```python
import torch

def _softmax(x, axis=-1):
    return torch.softmax(x, dim=axis)
def _gelu(x):
    return torch.nn.functional.gelu(x, approximate="tanh")
def _silu(x):
    return torch.nn.functional.silu(x)
def _sigmoid(x):
    return torch.sigmoid(x)
def _layernorm(x, axis=-1, eps=1e-5):
    m = x.mean(dim=axis, keepdim=True)
    v = x.var(dim=axis, keepdim=True, unbiased=False)
    return (x - m) / torch.sqrt(v + eps)
def _scatter_add(tgt, idx, src, axis=0):
    return tgt.clone().index_add_(axis, idx, src)
def _segment_sum(src, seg, n):
    out = torch.zeros((n,) + src.shape[1:], dtype=src.dtype)
    return out.index_add_(0, seg, src)
def _pad(x, pw):
    flat = tuple(v for pair in reversed(pw) for v in pair)
    return torch.nn.functional.pad(x, flat)

kernel_name = 'concat_heads__mha_block_cached__mha_block_cached__near_ridge'

def setup_inputs():

    _w = (lambda a: (lambda t: t.to(torch.bfloat16) if t.is_floating_point() else t)(torch.as_tensor(a)))
    def _A_setup():
        B, Sq, D = 8, 128, 1024
        H, Sk, Dh = 32, 1024, 128
        return {
            "x": _w((lambda *s: torch.randn(*s, dtype=torch.bfloat16) * 0.8)(B, Sq, D)),
            "k_cache": _w((lambda *s: torch.randn(*s, dtype=torch.bfloat16) * 0.8)(B, H, Sk, Dh)),
            "v_cache": _w((lambda *s: torch.randn(*s, dtype=torch.bfloat16) * 0.05)(B, H, Sk, Dh)),
            "wq": _w((lambda *s: torch.randn(*s, dtype=torch.bfloat16) * 0.8)(D, H * Dh) * (D ** -0.5)),
            "wo": _w((lambda *s: torch.randn(*s, dtype=torch.bfloat16) * 0.05)(H * Dh, D) * ((H * Dh) ** -0.5)),
        }
    _A_in = _A_setup()

    def _B_setup():
        B, Sq, D = 8, 128, 1024
        H, Sk, Dh = 32, 1024, 128
        return {
            "x": _w((lambda *s: torch.randn(*s, dtype=torch.bfloat16) * 0.8)(B, Sq, D)),
            "k_cache": _w((lambda *s: torch.randn(*s, dtype=torch.bfloat16) * 0.8)(B, H, Sk, Dh)),
            "v_cache": _w((lambda *s: torch.randn(*s, dtype=torch.bfloat16) * 0.05)(B, H, Sk, Dh)),
            "wq": _w((lambda *s: torch.randn(*s, dtype=torch.bfloat16) * 0.8)(D, H * Dh) * (D ** -0.5)),
            "wo": _w((lambda *s: torch.randn(*s, dtype=torch.bfloat16) * 0.05)(H * Dh, D) * ((H * Dh) ** -0.5)),
        }
    _B_in = _B_setup()

    return {
        "A_x": _A_in["x"],
        "A_k_cache": _A_in["k_cache"],
        "A_v_cache": _A_in["v_cache"],
        "A_wq": _A_in["wq"],
        "A_wo": _A_in["wo"],
        "B_x": _B_in["x"],
        "B_k_cache": _B_in["k_cache"],
        "B_v_cache": _B_in["v_cache"],
        "B_wq": _B_in["wq"],
        "B_wo": _B_in["wo"],
    }

def reference(A_x, A_k_cache, A_v_cache, A_wq, A_wo, B_x, B_k_cache, B_v_cache, B_wq, B_wo):
    def _A_ref(x, k_cache, v_cache, wq, wo):
        B, Sq, D = x.shape
        H, Dh = 32, 128
        q = (lambda x, *d: x.permute(*d))((x @ wq).reshape(B, Sq, H, Dh), 0, 2, 1, 3)
        scores = torch.einsum("bhqd,bhkd->bhqk", q, k_cache) * (Dh ** -0.5)
        p = _softmax(scores, axis=-1)
        o = torch.einsum("bhqk,bhkd->bhqd", p, v_cache)
        return (lambda x, *d: x.permute(*d))(o, 0, 2, 1, 3).reshape(B, Sq, H * Dh) @ wo

    def _B_ref(x, k_cache, v_cache, wq, wo):
        B, Sq, D = x.shape
        H, Dh = 32, 128
        q = (lambda x, *d: x.permute(*d))((x @ wq).reshape(B, Sq, H, Dh), 0, 2, 1, 3)
        scores = torch.einsum("bhqd,bhkd->bhqk", q, k_cache) * (Dh ** -0.5)
        p = _softmax(scores, axis=-1)
        o = torch.einsum("bhqk,bhkd->bhqd", p, v_cache)
        return (lambda x, *d: x.permute(*d))(o, 0, 2, 1, 3).reshape(B, Sq, H * Dh) @ wo

    a = _A_ref(A_x, A_k_cache, A_v_cache, A_wq, A_wo)
    b = _B_ref(B_x, B_k_cache, B_v_cache, B_wq, B_wo)
    return torch.concatenate([a, b], axis=-1)
```

```asm
; @launch grid=(256,1,1) block=(256,1,1) lds=163840
.amdgcn_target "amdgcn-amd-amdhsa--gfx950"
.text
.globl concat_heads__mha_block_cached__mha_block_cached__near_ridge_kernel
.p2align 8
.type concat_heads__mha_block_cached__mha_block_cached__near_ridge_kernel,@function
concat_heads__mha_block_cached__mha_block_cached__near_ridge_kernel:
    s_cmp_ge_u32 s2, 256
    s_cbranch_scc1 Lend
    s_bfe_u32 s55, s2, 0x10002
    s_mul_i32 s3, s55, 40
    s_load_dwordx8 s[84:91], s[0:1], s3
    s_add_u32 s3, s3, 32
    s_load_dwordx2 s[92:93], s[0:1], s3
    s_load_dwordx4 s[96:99], s[0:1], 88
    s_load_dwordx2 s[94:95], s[0:1], 80
    v_lshrrev_b32 v1, 6, v0
    v_and_b32 v0, 63, v0
    v_readfirstlane_b32 s67, v1
    s_lshr_b32 s61, s2, 3
    s_and_b32 s58, s2, 3
    s_and_b32 s50, s61, 7
    s_lshr_b32 s54, s61, 3
    s_lshl_b32 s57, s58, 2
    s_add_u32 s57, s57, s54
    s_lshl_b32 s57, s57, 1
    s_lshl_b32 s44, s67, 12
    s_lshl_b32 s66, s54, 0
    s_lshl_b32 s62, s50, 0
    s_add_u32 s66, s66, s62
    s_and_b32 s66, s66, 3
    s_lshl_b32 s66, s66, 7
    s_lshl_b32 s53, s57, 8
    s_mov_b32 s62, 0
    s_xor_b32 s51, s62, s66
    s_lshl_b32 s52, s51, 12
    s_add_u32 s52, s52, s53
    v_lshrrev_b32 v1, 4, v0
    v_and_b32 v2, 15, v0
    v_lshrrev_b32 v11, 3, v0
    v_and_b32 v12, 7, v0
    s_lshl_b32 s72, s67, 16
    v_lshlrev_b32 v11, 11, v11
    v_add_u32 v11, s72, v11
    v_xor_b32 v5, v12, v1
    v_lshl_add_u32 v211, v5, 4, v11
    v_xor_b32 v212, 64, v211
    v_add_u32 v213, 30720, v211
    v_add_u32 v214, 46080, v212
    v_add_u32 v212, 15360, v212
    v_lshlrev_b32 v3, 2, v1
    v_xor_b32 v3, v3, v2
    v_lshlrev_b32 v3, 4, v3
    v_lshl_add_u32 v4, v1, 13, v3
    s_lshl_b32 s72, s67, 17
    v_add_u32 v215, s72, v4
    v_add_u32 v216, 31744, v215
    v_add_u32 v217, 63488, v215
    v_add_u32 v218, 95232, v215
    s_lshl_b32 s72, s50, 18
    s_mov_b32 s45, 0
    s_waitcnt lgkmcnt(0)
    s_add_u32 s4, s84, s72
    s_addc_u32 s5, s85, 0
    s_mov_b32 s6, 0x40000
    s_mov_b32 s7, 0x20000
    s_mov_b32 s8, s90
    s_mov_b32 s9, s91
    s_mov_b32 s10, 0x800000
    s_mov_b32 s11, 0x20000
    s_mov_b32 s76, 0x28000
    s_mov_b32 s47, 3
Llp_1:
    s_add_u32 m0, s45, s44
    s_add_u32 s45, s45, 0x8000
    s_cmp_eq_u32 s45, s76
    s_cselect_b32 s45, 0, s45
    buffer_load_dwordx4 v211, s[4:7], s51 offen offset:0 lds
    buffer_load_dwordx4 v212, s[4:7], s51 offen offset:1024 lds
    buffer_load_dwordx4 v213, s[4:7], s51 offen offset:2048 lds
    buffer_load_dwordx4 v214, s[4:7], s51 offen offset:3072 lds
    s_add_u32 m0, m0, 0x4000
    s_nop 0
    buffer_load_dwordx4 v215, s[8:11], s52 offen offset:0 lds
    buffer_load_dwordx4 v216, s[8:11], s52 offen offset:1024 lds
    buffer_load_dwordx4 v217, s[8:11], s52 offen offset:2048 lds
    buffer_load_dwordx4 v218, s[8:11], s52 offen offset:3072 lds
    s_add_u32 s62, s62, 0x80
    s_xor_b32 s51, s62, s66
    s_lshl_b32 s52, s51, 12
    s_add_u32 s52, s52, s53
    s_sub_u32 s47, s47, 1
    s_cbranch_scc0 Llp_1
    s_add_u32 m0, s45, s44
    s_add_u32 s45, s45, 0x8000
    s_cmp_eq_u32 s45, s76
    s_cselect_b32 s45, 0, s45
    s_getpc_b64 s[12:13]
Lpc0:
    s_mov_b32 s14, Lcodeend-Lpc0
    s_mov_b32 s15, 0x20000
    v_lshl_add_u32 v4, s67, 6, v0
    v_lshlrev_b32 v4, 7, v4
    buffer_load_dword v227, v4, s[12:15], 0 offen
    v_lshl_add_u32 v4, v1, 8, v3
    v_add_u32 v210, s44, v4
    s_lshl_b32 s72, s67, 2
    v_or_b32 v3, s72, v1
    v_xor_b32 v3, v3, v2
    v_lshlrev_b32 v3, 4, v3
    v_lshl_add_u32 v3, v1, 8, v3
    v_add_u32 v209, s44, v3
    v_and_b32 v5, 1, v1
    v_lshlrev_b32 v5, 2, v5
    v_xor_b32 v5, v5, v12
    v_lshl_add_u32 v219, v5, 4, v11
    v_add_u32 v220, 15360, v219
    v_add_u32 v221, 30720, v219
    v_add_u32 v222, 46080, v219
    s_lshr_b32 s56, s58, 1
    s_lshl_b32 s56, s56, 2
    s_and_b32 s72, s61, 3
    s_add_u32 s56, s56, s72
    s_and_b32 s59, s58, 1
    s_lshl_b32 s59, s59, 3
    s_lshr_b32 s73, s61, 2
    s_add_u32 s59, s59, s73
    s_lshl_b32 s72, s72, 0
    s_add_u32 s71, s72, s59
    s_and_b32 s71, s71, 3
    s_lshl_b32 s72, s50, 5
    s_add_u32 s72, s72, s57
    s_lshl_b32 s73, s72, 18
    s_add_u32 s12, s86, s73
    s_addc_u32 s13, s87, 0
    s_mov_b32 s14, 0x80000
    s_mov_b32 s15, 0x20000
    s_add_u32 s16, s88, s73
    s_addc_u32 s17, s89, 0
    s_mov_b32 s18, 0x80000
    s_mov_b32 s19, 0x20000
    s_lshl_b32 s73, s55, 8
    s_add_u32 s72, s72, s73
    s_lshl_b32 s72, s72, 15
    s_add_u32 s24, s98, s72
    s_addc_u32 s25, s99, 0
    s_mov_b32 s26, 0x10000
    s_mov_b32 s27, 0x20000
    s_lshl_b32 s72, s55, 3
    s_add_u32 s69, s72, s50
    s_mul_i32 s100, s69, 4352
    s_lshl_b32 s73, s57, 1
    s_add_u32 s100, s100, s73
    s_lshl_b32 s69, s69, 4
    s_add_u32 s70, s72, s56
    s_mul_i32 s101, s70, 4352
    s_lshl_b32 s72, s70, 20
    s_lshl_b32 s70, s70, 4
    s_add_u32 s28, s98, s72
    s_addc_u32 s29, s99, 0
    s_mov_b32 s30, 0x100000
    s_mov_b32 s31, 0x20000
    s_lshl_b32 s72, s59, 7
    s_add_u32 s20, s92, s72
    s_addc_u32 s21, s93, 0
    s_sub_u32 s22, 0x800000, s72
    s_mov_b32 s23, 0x20000
    s_lshl_b32 s73, s56, 19
    s_add_u32 s72, s72, s73
    s_lshl_b32 s73, s55, 11
    s_add_u32 s72, s72, s73
    s_add_u32 s32, s94, s72
    s_addc_u32 s33, s95, 0
    s_sub_u32 s34, 0x400000, s72
    s_mov_b32 s35, 0x20000
    s_mov_b32 s36, s96
    s_mov_b32 s37, s97
    s_mov_b32 s38, 0x100
    s_mov_b32 s39, 0x20000
    s_add_u32 s96, s98, 0x1000000
    s_addc_u32 s97, s99, 0
    s_mov_b32 s98, 0x11000
    s_mov_b32 s99, 0x20000
    s_mov_b32 s3, 0x40000000
    s_mov_b32 s48, 0
    s_mov_b32 s49, s3
    s_mov_b32 s68, 0
    s_mov_b32 s74, 0x3e0293ee
    s_mov_b32 s75, s74
    s_mov_b32 s64, 0x40004000
    v_lshrrev_b32 v6, 5, v0
    v_bfe_u32 v7, v0, 2, 2
    v_and_b32 v8, 3, v0
    v_and_b32 v9, 1, v1
    v_bfe_u32 v3, v0, 3, 2
    v_and_b32 v4, 7, v0
    v_lshl_add_u32 v4, v3, 4, v4
    v_lshl_add_u32 v5, v3, 2, v8
    v_xor_b32 v5, v5, v6
    v_lshlrev_b32 v5, 4, v5
    v_lshl_add_u32 v204, v4, 8, v5
    v_lshl_add_u32 v3, v6, 2, v7
    v_lshlrev_b32 v4, 6, v7
    v_lshl_add_u32 v4, v9, 5, v4
    v_lshl_add_u32 v5, v3, 8, v4
    v_lshl_add_u32 v205, v8, 3, v5
    v_and_b32 v10, 1, v8
    v_lshlrev_b32 v10, 4, v10
    v_lshrrev_b32 v5, 1, v8
    v_lshl_add_u32 v10, v5, 3, v10
    v_lshl_add_u32 v5, v6, 3, v7
    v_lshl_add_u32 v5, v5, 8, v4
    v_add_u32 v207, v5, v10
    v_lshrrev_b32 v4, 1, v7
    v_lshlrev_b32 v4, 6, v4
    v_lshl_add_u32 v4, v9, 5, v4
    v_lshl_add_u32 v4, v3, 7, v4
    v_add_u32 v208, v4, v10
    v_and_b32 v3, 31, v0
    v_bfe_u32 v4, v0, 1, 3
    v_xor_b32 v4, v4, v6
    v_lshlrev_b32 v4, 4, v4
    v_lshl_add_u32 v4, v3, 7, v4
    v_add_u32 v206, s44, v4
    s_lshl_b32 s72, s67, 13
    v_lshlrev_b32 v4, 4, v0
    v_add_u32 v223, s72, v4
    v_add_u32 v224, 0x1000, v223
    s_lshl_b32 s72, s67, 17
    v_lshlrev_b32 v4, 4, v6
    v_lshl_add_u32 v4, v3, 12, v4
    v_add_u32 v225, s72, v4
    v_lshlrev_b32 v255, 2, v0
    v_and_b32 v255, 60, v255
    v_lshrrev_b32 v4, 2, v0
    v_xor_b32 v4, v4, v1
    v_and_b32 v4, 1, v4
    v_add_u32 v4, -1, v4
    v_and_b32 v4, 0x3f803f80, v4
    v_accvgpr_write_b32 a168, v4
    v_accvgpr_write_b32 a172, 0
    v_accvgpr_write_b32 a169, v4
    v_accvgpr_write_b32 a173, 0
    v_accvgpr_write_b32 a170, v4
    v_accvgpr_write_b32 a174, 0
    v_accvgpr_write_b32 a171, v4
    v_accvgpr_write_b32 a175, 0
    s_nop 1
    v_mfma_f32_32x32x16_bf16 a[64:79], a[168:171], a[172:175], 0
    v_mfma_f32_32x32x16_bf16 a[80:95], a[168:171], a[172:175], 0
    v_mfma_f32_32x32x16_bf16 a[96:111], a[168:171], a[172:175], 0
    v_mfma_f32_32x32x16_bf16 a[112:127], a[168:171], a[172:175], 0
    v_mfma_f32_32x32x16_bf16 a[152:167], a[168:171], a[172:175], 0
    v_mfma_f32_32x32x16_bf16 v[80:95], a[168:171], a[172:175], 0
    v_mfma_f32_32x32x16_bf16 v[96:111], a[168:171], a[172:175], 0
    v_mfma_f32_32x32x16_bf16 v[112:127], a[168:171], a[172:175], 0
    v_mfma_f32_32x32x16_bf16 v[0:15], a[168:171], a[172:175], 0
    v_mfma_f32_32x32x16_bf16 v[16:31], a[168:171], a[172:175], 0
    v_mfma_f32_32x32x16_bf16 v[32:47], a[168:171], a[172:175], 0
    v_mfma_f32_32x32x16_bf16 v[48:63], a[168:171], a[172:175], 0
    v_mfma_f32_16x16x32_bf16 v[228:231], a[168:171], a[172:175], 0
    s_cmp_lg_u32 s67, 0
    s_cbranch_scc1 Lsg_2
    v_mov_b32 v236, 0
    s_mov_b64 exec, 1
    buffer_store_dword v236, off, s[96:99], s100 offset:0 sc1
    buffer_store_dword v236, off, s[96:99], s100 offset:2176 sc1
    s_mov_b64 exec, -1
Lsg_2:
    v_accvgpr_write_b32 a148, 0
    v_accvgpr_write_b32 a149, 0
    v_accvgpr_write_b32 a150, 0
    v_accvgpr_write_b32 a151, 0
    v_mfma_f32_32x32x16_bf16 v[128:143], a[168:171], a[172:175], 0
    v_mfma_f32_32x32x16_bf16 v[144:159], a[168:171], a[172:175], 0
    v_mfma_f32_32x32x16_bf16 v[160:175], a[168:171], a[172:175], 0
    v_mfma_f32_32x32x16_bf16 v[176:191], a[168:171], a[172:175], 0
    s_mov_b32 s47, 11
    s_call_b64 s[40:41], LQQ0
    s_add_u32 s53, s53, 256
    s_mov_b32 s62, 0
    s_xor_b32 s66, s66, 1536
    s_xor_b32 s51, s62, s66
    s_lshl_b32 s52, s51, 12
    s_add_u32 s52, s52, s53
    s_cmp_lg_u32 s67, 0
    s_cbranch_scc1 Lsg_3
    v_mov_b32 v236, 1
    s_mov_b64 exec, 1
    buffer_atomic_add v236, off, s[36:39], s69 sc1
    s_mov_b64 exec, -1
Lsg_3:
    s_mov_b32 s47, 0
    s_call_b64 s[40:41], LQA1
    s_mov_b32 s47, 0
    s_call_b64 s[40:41], LQQ0
    s_mov_b32 s47, 0
    s_call_b64 s[40:41], LQA1
    s_mov_b32 s47, 0
    s_call_b64 s[40:41], LQQ0
    s_call_b64 s[40:41], LQF
    v_accvgpr_write_b32 a148, 0
    v_accvgpr_write_b32 a149, 0
    v_accvgpr_write_b32 a150, 0
    v_accvgpr_write_b32 a151, 0
    v_mfma_f32_32x32x16_bf16 v[128:143], a[168:171], a[172:175], 0
    v_mfma_f32_32x32x16_bf16 v[144:159], a[168:171], a[172:175], 0
    v_mfma_f32_32x32x16_bf16 v[160:175], a[168:171], a[172:175], 0
    v_mfma_f32_32x32x16_bf16 v[176:191], a[168:171], a[172:175], 0
    s_mov_b32 s47, 13
Llp_4:
    s_waitcnt vmcnt(24) lgkmcnt(0)
    v_mfma_f32_32x32x16_bf16 v[0:15], a[64:67], v[96:99], v[0:15]
    s_barrier
    v_add_u32 v192, s45, v204
    v_xor_b32 v193, 32, v192
    v_xor_b32 v194, 64, v192
    v_xor_b32 v195, 96, v192
    v_mfma_f32_32x32x16_bf16 v[16:31], a[68:71], v[96:99], v[16:31]
    ds_read_b128 a[32:35], v192 offset:0
    ds_read_b128 a[36:39], v193 offset:0
    v_xor_b32 v196, 128, v192
    v_xor_b32 v197, 160, v192
    v_exp_f32 v232, v80
    v_mfma_f32_32x32x16_bf16 v[32:47], a[72:75], v[96:99], v[32:47]
    ds_read_b128 a[40:43], v194 offset:0
    ds_read_b128 a[44:47], v195 offset:0
    v_xor_b32 v198, 192, v192
    v_xor_b32 v199, 224, v192
    v_exp_f32 v233, v81
    v_mfma_f32_32x32x16_bf16 v[48:63], a[76:79], v[96:99], v[48:63]
    ds_read_b128 a[48:51], v196 offset:0
    ds_read_b128 a[52:55], v197 offset:0
    v_exp_f32 v234, v82
    v_cvt_pk_bf16_f32 v104, v232, v233
    v_mfma_f32_32x32x16_bf16 v[0:15], a[80:83], v[100:103], v[0:15]
    ds_read_b128 a[56:59], v198 offset:0
    ds_read_b128 a[60:63], v199 offset:0
    v_exp_f32 v235, v83
    v_exp_f32 v232, v84
    v_mfma_f32_16x16x32_bf16 v[228:231], a[168:171], v[96:99], v[228:231]
    v_add_u32 v200, s45, v205
    v_xor_b32 v201, 64, v200
    v_mfma_f32_32x32x16_bf16 v[16:31], a[84:87], v[100:103], v[16:31]
    buffer_load_dwordx4 v209, s[12:15], s48 offen offset:0 nt lds
    v_cvt_pk_bf16_f32 v105, v234, v235
    v_exp_f32 v233, v85
    v_mfma_f32_32x32x16_bf16 v[32:47], a[88:91], v[100:103], v[32:47]
    v_exp_f32 v234, v86
    v_cvt_pk_bf16_f32 v106, v232, v233
    v_exp_f32 v235, v87
    v_or3_b32 v226, v104, v105, v106
    v_mfma_f32_16x16x32_bf16 v[228:231], a[168:171], v[100:103], v[228:231]
    v_xor_b32 v202, 128, v200
    v_xor_b32 v203, 192, v200
    v_mfma_f32_32x32x16_bf16 v[48:63], a[92:95], v[100:103], v[48:63]
    buffer_load_dwordx4 v209, s[12:15], s48 offen offset:1024 nt lds
    v_exp_f32 v232, v88
    v_cvt_pk_bf16_f32 v107, v234, v235
    s_waitcnt lgkmcnt(0)
    v_mfma_f32_32x32x16_bf16 v[64:79], a[32:35], a[0:3], v[112:127]
    ds_read_b64_tr_b16 a[64:65], v200 offset:18432
    ds_read_b64_tr_b16 a[66:67], v200 offset:22528
    ds_read_b64_tr_b16 a[68:69], v201 offset:18432
    v_exp_f32 v233, v89
    v_mfma_f32_32x32x16_bf16 v[64:79], a[36:39], a[4:7], v[64:79]
    ds_read_b64_tr_b16 a[70:71], v201 offset:22528
    ds_read_b64_tr_b16 a[72:73], v202 offset:18432
    ds_read_b64_tr_b16 a[74:75], v202 offset:22528
    v_exp_f32 v234, v90
    v_cvt_pk_bf16_f32 v108, v232, v233
    v_mfma_f32_32x32x16_bf16 v[64:79], a[40:43], a[8:11], v[64:79]
    ds_read_b64_tr_b16 a[76:77], v203 offset:18432
    ds_read_b64_tr_b16 a[78:79], v203 offset:22528
    ds_read_b64_tr_b16 a[80:81], v200 offset:26624
    v_exp_f32 v235, v91
    v_or3_b32 v226, v226, v107, v108
    v_mfma_f32_32x32x16_bf16 v[64:79], a[44:47], a[12:15], v[64:79]
    ds_read_b64_tr_b16 a[82:83], v200 offset:30720
    ds_read_b64_tr_b16 a[84:85], v201 offset:26624
    ds_read_b64_tr_b16 a[86:87], v201 offset:30720
    v_exp_f32 v232, v92
    v_cvt_pk_bf16_f32 v109, v234, v235
    v_mfma_f32_32x32x16_bf16 v[64:79], a[48:51], a[16:19], v[64:79]
    ds_read_b64_tr_b16 a[88:89], v202 offset:26624
    ds_read_b64_tr_b16 a[90:91], v202 offset:30720
    v_exp_f32 v233, v93
    v_mfma_f32_32x32x16_bf16 v[64:79], a[52:55], a[20:23], v[64:79]
    ds_read_b64_tr_b16 a[92:93], v203 offset:26624
    ds_read_b64_tr_b16 a[94:95], v203 offset:30720
    buffer_load_dwordx4 v209, s[12:15], s48 offen offset:2048 nt lds
    v_exp_f32 v234, v94
    v_cvt_pk_bf16_f32 v110, v232, v233
    v_mfma_f32_32x32x16_bf16 v[64:79], a[56:59], a[24:27], v[64:79]
    v_exp_f32 v235, v95
    v_or3_b32 v226, v226, v109, v110
    v_cvt_pk_bf16_f32 v111, v234, v235
    v_bitop3_b32 v226, v226, s65, v111 bitop3:0xc8
    v_cmp_ne_u32 vcc, 0, v226
    v_mfma_f32_32x32x16_bf16 v[64:79], a[60:63], a[28:31], v[64:79]
    buffer_load_dwordx4 v209, s[12:15], s48 offen offset:3072 nt lds
    s_cbranch_vccnz Ltr_5
Lbk_6:
    s_waitcnt lgkmcnt(0)
    v_mfma_f32_32x32x16_bf16 v[0:15], a[64:67], v[104:107], v[0:15]
    ds_read_b128 a[32:35], v192 offset:2048
    ds_read_b128 a[36:39], v193 offset:2048
    s_add_u32 m0, m0, 0x4000
    v_mfma_f32_32x32x16_bf16 v[16:31], a[68:71], v[104:107], v[16:31]
    ds_read_b128 a[40:43], v194 offset:2048
    ds_read_b128 a[44:47], v195 offset:2048
    v_exp_f32 v232, v64
    v_mfma_f32_32x32x16_bf16 v[32:47], a[72:75], v[104:107], v[32:47]
    ds_read_b128 a[48:51], v196 offset:2048
    ds_read_b128 a[52:55], v197 offset:2048
    v_exp_f32 v233, v65
    v_exp_f32 v234, v66
    v_mfma_f32_32x32x16_bf16 v[48:63], a[76:79], v[104:107], v[48:63]
    ds_read_b128 a[56:59], v198 offset:2048
    ds_read_b128 a[60:63], v199 offset:2048
    v_cvt_pk_bf16_f32 v96, v232, v233
    v_exp_f32 v235, v67
    v_mfma_f32_32x32x16_bf16 v[0:15], a[80:83], v[108:111], v[0:15]
    v_exp_f32 v232, v68
    v_cvt_pk_bf16_f32 v97, v234, v235
    v_exp_f32 v233, v69
    v_mfma_f32_16x16x32_bf16 v[228:231], a[168:171], v[104:107], v[228:231]
    s_add_u32 s46, s45, s44
    s_add_u32 s45, s45, 0x8000
    v_mfma_f32_32x32x16_bf16 v[16:31], a[84:87], v[108:111], v[16:31]
    buffer_load_dwordx4 v210, s[16:19], s48 offen offset:0 nt lds
    v_exp_f32 v234, v70
    v_cvt_pk_bf16_f32 v98, v232, v233
    v_mfma_f32_32x32x16_bf16 v[32:47], a[88:91], v[108:111], v[32:47]
    v_exp_f32 v235, v71
    v_or3_b32 v226, v96, v97, v98
    v_exp_f32 v232, v72
    v_cvt_pk_bf16_f32 v99, v234, v235
    v_mfma_f32_16x16x32_bf16 v[228:231], a[168:171], v[108:111], v[228:231]
    s_cmp_eq_u32 s45, s76
    s_cselect_b32 s45, 0, s45
    v_mfma_f32_32x32x16_bf16 v[48:63], a[92:95], v[108:111], v[48:63]
    buffer_load_dwordx4 v210, s[16:19], s48 offen offset:1024 nt lds
    v_exp_f32 v233, v73
    s_waitcnt lgkmcnt(0)
    v_mfma_f32_32x32x16_bf16 v[80:95], a[32:35], a[0:3], v[112:127]
    ds_read_b64_tr_b16 a[64:65], v200 offset:16384
    ds_read_b64_tr_b16 a[66:67], v200 offset:20480
    ds_read_b64_tr_b16 a[68:69], v201 offset:16384
    v_exp_f32 v234, v74
    v_cvt_pk_bf16_f32 v100, v232, v233
    v_mfma_f32_32x32x16_bf16 v[80:95], a[36:39], a[4:7], v[80:95]
    ds_read_b64_tr_b16 a[70:71], v201 offset:20480
    ds_read_b64_tr_b16 a[72:73], v202 offset:16384
    ds_read_b64_tr_b16 a[74:75], v202 offset:20480
    v_exp_f32 v235, v75
    v_or3_b32 v226, v226, v99, v100
    v_mfma_f32_32x32x16_bf16 v[80:95], a[40:43], a[8:11], v[80:95]
    ds_read_b64_tr_b16 a[76:77], v203 offset:16384
    ds_read_b64_tr_b16 a[78:79], v203 offset:20480
    ds_read_b64_tr_b16 a[80:81], v200 offset:24576
    v_exp_f32 v232, v76
    v_mfma_f32_32x32x16_bf16 v[80:95], a[44:47], a[12:15], v[80:95]
    ds_read_b64_tr_b16 a[82:83], v200 offset:28672
    ds_read_b64_tr_b16 a[84:85], v201 offset:24576
    ds_read_b64_tr_b16 a[86:87], v201 offset:28672
    v_cvt_pk_bf16_f32 v101, v234, v235
    v_mfma_f32_32x32x16_bf16 v[80:95], a[48:51], a[16:19], v[80:95]
    ds_read_b64_tr_b16 a[88:89], v202 offset:24576
    ds_read_b64_tr_b16 a[90:91], v202 offset:28672
    v_exp_f32 v233, v77
    v_exp_f32 v234, v78
    v_mfma_f32_32x32x16_bf16 v[80:95], a[52:55], a[20:23], v[80:95]
    ds_read_b64_tr_b16 a[92:93], v203 offset:24576
    ds_read_b64_tr_b16 a[94:95], v203 offset:28672
    buffer_load_dwordx4 v210, s[16:19], s49 offen offset:2048 nt lds
    v_cvt_pk_bf16_f32 v102, v232, v233
    v_exp_f32 v235, v79
    v_mfma_f32_32x32x16_bf16 v[80:95], a[56:59], a[24:27], v[80:95]
    v_or3_b32 v226, v226, v101, v102
    v_cvt_pk_bf16_f32 v103, v234, v235
    v_bitop3_b32 v226, v226, s64, v103 bitop3:0xc8
    v_cmp_ne_u32 vcc, s63, v226
    v_mfma_f32_32x32x16_bf16 v[80:95], a[60:63], a[28:31], v[80:95]
    buffer_load_dwordx4 v210, s[16:19], s49 offen offset:3072 nt lds
    s_mov_b32 s49, s48
    s_add_u32 s48, s48, 0x4000
    s_mov_b32 m0, s46
    s_cbranch_vccnz Ltr_7
Lbk_8:
    v_add_u32 v192, s45, v206
    v_add_u32 v196, s45, v207
    v_xor_b32 v197, 64, v196
    s_waitcnt vmcnt(24) lgkmcnt(0)
    v_mfma_f32_32x32x16_bf16 v[128:143], a[152:155], a[148:151], v[128:143]
    s_barrier
    ds_read_b128 a[128:131], v192
    ds_read_b64_tr_b16 a[132:133], v196 offset:16384
    ds_read_b64_tr_b16 a[134:135], v196 offset:17408
    v_xor_b32 v198, 128, v196
    v_xor_b32 v199, 192, v196
    v_mfma_f32_32x32x16_bf16 v[144:159], a[156:159], a[148:151], v[144:159]
    ds_read_b64_tr_b16 a[136:137], v197 offset:16384
    ds_read_b64_tr_b16 a[138:139], v197 offset:17408
    ds_read_b64_tr_b16 a[140:141], v198 offset:16384
    v_xor_b32 v193, 32, v192
    v_xor_b32 v194, 64, v192
    v_xor_b32 v195, 96, v192
    v_mfma_f32_32x32x16_bf16 v[160:175], a[160:163], a[148:151], v[160:175]
    ds_read_b64_tr_b16 a[142:143], v198 offset:17408
    ds_read_b64_tr_b16 a[144:145], v199 offset:16384
    ds_read_b64_tr_b16 a[146:147], v199 offset:17408
    v_mfma_f32_32x32x16_bf16 v[176:191], a[164:167], a[148:151], v[176:191]
    buffer_load_dwordx4 v211, s[4:7], s51 offen offset:0 lds
    s_add_u32 s46, s45, s44
    s_add_u32 s45, s45, 0x8000
    buffer_load_dwordx4 v212, s[4:7], s51 offen offset:1024 lds
    s_waitcnt lgkmcnt(3)
    v_mfma_f32_32x32x16_bf16 v[128:143], a[132:135], a[128:131], v[128:143]
    ds_read_b128 a[148:151], v193
    ds_read_b64_tr_b16 a[152:153], v196 offset:20480
    ds_read_b64_tr_b16 a[154:155], v196 offset:21504
    v_mfma_f32_32x32x16_bf16 v[144:159], a[136:139], a[128:131], v[144:159]
    ds_read_b64_tr_b16 a[156:157], v197 offset:20480
    ds_read_b64_tr_b16 a[158:159], v197 offset:21504
    ds_read_b64_tr_b16 a[160:161], v198 offset:20480
    s_waitcnt lgkmcnt(6)
    v_mfma_f32_32x32x16_bf16 v[160:175], a[140:143], a[128:131], v[160:175]
    ds_read_b64_tr_b16 a[162:163], v198 offset:21504
    ds_read_b64_tr_b16 a[164:165], v199 offset:20480
    ds_read_b64_tr_b16 a[166:167], v199 offset:21504
    v_mfma_f32_32x32x16_bf16 v[176:191], a[144:147], a[128:131], v[176:191]
    buffer_load_dwordx4 v213, s[4:7], s51 offen offset:2048 lds
    s_cmp_eq_u32 s45, s76
    s_cselect_b32 s45, 0, s45
    buffer_load_dwordx4 v214, s[4:7], s51 offen offset:3072 lds
    s_add_u32 m0, m0, 0x4000
    s_waitcnt lgkmcnt(3)
    v_mfma_f32_32x32x16_bf16 v[128:143], a[152:155], a[148:151], v[128:143]
    ds_read_b128 a[128:131], v194
    ds_read_b64_tr_b16 a[132:133], v196 offset:24576
    ds_read_b64_tr_b16 a[134:135], v196 offset:25600
    v_mfma_f32_32x32x16_bf16 v[144:159], a[156:159], a[148:151], v[144:159]
    ds_read_b64_tr_b16 a[136:137], v197 offset:24576
    ds_read_b64_tr_b16 a[138:139], v197 offset:25600
    ds_read_b64_tr_b16 a[140:141], v198 offset:24576
    s_waitcnt lgkmcnt(6)
    v_mfma_f32_32x32x16_bf16 v[160:175], a[160:163], a[148:151], v[160:175]
    ds_read_b64_tr_b16 a[142:143], v198 offset:25600
    ds_read_b64_tr_b16 a[144:145], v199 offset:24576
    ds_read_b64_tr_b16 a[146:147], v199 offset:25600
    v_mfma_f32_32x32x16_bf16 v[176:191], a[164:167], a[148:151], v[176:191]
    buffer_load_dwordx4 v215, s[8:11], s52 offen offset:0 lds
    buffer_load_dwordx4 v216, s[8:11], s52 offen offset:1024 lds
    s_waitcnt lgkmcnt(3)
    v_mfma_f32_32x32x16_bf16 v[128:143], a[132:135], a[128:131], v[128:143]
    ds_read_b128 a[148:151], v195
    ds_read_b64_tr_b16 a[152:153], v196 offset:28672
    ds_read_b64_tr_b16 a[154:155], v196 offset:29696
    v_mfma_f32_32x32x16_bf16 v[144:159], a[136:139], a[128:131], v[144:159]
    ds_read_b64_tr_b16 a[156:157], v197 offset:28672
    ds_read_b64_tr_b16 a[158:159], v197 offset:29696
    ds_read_b64_tr_b16 a[160:161], v198 offset:28672
    s_waitcnt lgkmcnt(6)
    v_mfma_f32_32x32x16_bf16 v[160:175], a[140:143], a[128:131], v[160:175]
    ds_read_b64_tr_b16 a[162:163], v198 offset:29696
    ds_read_b64_tr_b16 a[164:165], v199 offset:28672
    ds_read_b64_tr_b16 a[166:167], v199 offset:29696
    v_mfma_f32_32x32x16_bf16 v[176:191], a[144:147], a[128:131], v[176:191]
    buffer_load_dwordx4 v217, s[8:11], s52 offen offset:2048 lds
    buffer_load_dwordx4 v218, s[8:11], s52 offen offset:3072 lds
    s_add_u32 s62, s62, 0x80
    s_xor_b32 s51, s62, s66
    s_lshl_b32 s52, s51, 12
    s_add_u32 s52, s52, s53
    s_mov_b32 m0, s46
    s_sub_u32 s47, s47, 1
    s_cbranch_scc0 Llp_4
    buffer_load_dword v227, off, s[36:39], s70 sc1
    s_mov_b32 s47, 0
    s_call_b64 s[40:41], LAA2
    s_mov_b32 s47, 0
    s_call_b64 s[40:41], LQA1
    s_mov_b32 s47, 0
    s_call_b64 s[40:41], LAA2
    s_mov_b32 s47, 0
    s_call_b64 s[40:41], LQA1
    s_cmp_lg_u32 s67, 0
    s_cbranch_scc1 Lpd_11
    s_mov_b32 s73, 0x20000
    s_waitcnt vmcnt(32)
    s_branch Lpc_10
Lpl_9:
    buffer_load_dword v227, off, s[36:39], s70 sc1
    s_waitcnt vmcnt(0)
Lpc_10:
    v_cmp_gt_u32 vcc, 16, v227
    s_sub_u32 s73, s73, 1
    s_cbranch_scc1 Lpd_11
    s_cbranch_vccz Lpd_11
    s_sleep 8
    s_branch Lpl_9
Lpd_11:
    s_lshl_b32 s55, s71, 20
    s_add_u32 s55, s55, 0x0
    s_add_u32 s56, s55, 0x80000
    s_mov_b32 s57, s55
    s_mov_b32 s54, 0
    s_waitcnt vmcnt(24)
    s_call_b64 s[40:41], LE
    s_call_b64 s[40:41], LQF
    s_mov_b32 s47, 1
    s_call_b64 s[40:41], LAA2
    s_waitcnt vmcnt(16)
    s_barrier
    s_cmp_lg_u32 s67, 0
    s_cbranch_scc1 Lsg_12
    v_mov_b32 v236, 1
    s_mov_b64 exec, 1
    buffer_store_dword v236, off, s[96:99], s100 offset:0 sc1
    s_mov_b64 exec, -1
Lsg_12:
    s_mov_b32 s47, 1
    s_call_b64 s[40:41], LAA2
    s_mov_b32 s47, 0
    s_call_b64 s[40:41], LAP3
    s_mov_b32 s47, 0
    s_call_b64 s[40:41], LAA2
    buffer_load_dword v227, v255, s[96:99], s101 offen offset:0 sc1
    s_mov_b32 s47, 0
    s_call_b64 s[40:41], LAP3
    s_cmp_lg_u32 s67, 0
    s_cbranch_scc1 Lpd_15
    s_mov_b32 s73, 0x20000
    s_waitcnt vmcnt(8)
    s_branch Lpc_14
Lpl_13:
    buffer_load_dword v227, v255, s[96:99], s101 offen offset:0 sc1
    s_waitcnt vmcnt(0)
Lpc_14:
    v_cmp_gt_u32 vcc, 1, v227
    s_sub_u32 s73, s73, 1
    s_cbranch_scc1 Lpd_15
    s_cbranch_vccz Lpd_15
    s_sleep 8
    s_branch Lpl_13
Lpd_15:
    s_barrier
    s_lshl_b32 s59, s71, 17
    s_add_u32 s59, s59, 0x0
    s_add_u32 s60, s59, 0x10000
    s_mov_b32 s62, s59
    s_mov_b32 s61, 0
    buffer_load_dwordx4 v[128:131], v223, s[28:31], s59 offen offset:0 sc1
    buffer_load_dwordx4 v[132:135], v223, s[28:31], s59 offen offset:1024 sc1
    buffer_load_dwordx4 v[136:139], v223, s[28:31], s59 offen offset:2048 sc1
    buffer_load_dwordx4 v[140:143], v223, s[28:31], s59 offen offset:3072 sc1
    buffer_load_dwordx4 v[144:147], v224, s[28:31], s59 offen offset:0 sc1
    buffer_load_dwordx4 v[148:151], v224, s[28:31], s59 offen offset:1024 sc1
    buffer_load_dwordx4 v[152:155], v224, s[28:31], s59 offen offset:2048 sc1
    buffer_load_dwordx4 v[156:159], v224, s[28:31], s59 offen offset:3072 sc1
    buffer_load_dwordx4 v[160:163], v223, s[28:31], s60 offen offset:0 sc1
    buffer_load_dwordx4 v[164:167], v223, s[28:31], s60 offen offset:1024 sc1
    buffer_load_dwordx4 v[168:171], v223, s[28:31], s60 offen offset:2048 sc1
    buffer_load_dwordx4 v[172:175], v223, s[28:31], s60 offen offset:3072 sc1
    buffer_load_dwordx4 v[176:179], v224, s[28:31], s60 offen offset:0 sc1
    buffer_load_dwordx4 v[180:183], v224, s[28:31], s60 offen offset:1024 sc1
    buffer_load_dwordx4 v[184:187], v224, s[28:31], s60 offen offset:2048 sc1
    buffer_load_dwordx4 v[188:191], v224, s[28:31], s60 offen offset:3072 sc1
    s_add_u32 s61, s61, 0x20000
    s_xor_b32 s59, s61, s62
    s_add_u32 s60, s59, 0x10000
    s_mov_b32 s47, 0
    s_call_b64 s[40:41], LAA2
    s_mov_b32 s47, 5
Llp_16:
    v_add_u32 v192, s45, v208
    v_xor_b32 v193, 64, v192
    s_waitcnt vmcnt(41) lgkmcnt(0)
    s_barrier
    ds_read_b64_tr_b16 a[128:129], v192 offset:0
    ds_read_b64_tr_b16 a[130:131], v192 offset:1024
    ds_read_b64_tr_b16 a[132:133], v193 offset:0
    ds_read_b64_tr_b16 a[134:135], v193 offset:1024
    ds_read_b64_tr_b16 a[136:137], v192 offset:2048
    ds_read_b64_tr_b16 a[138:139], v192 offset:3072
    ds_read_b64_tr_b16 a[140:141], v193 offset:2048
    ds_read_b64_tr_b16 a[142:143], v193 offset:3072
    s_waitcnt vmcnt(22) lgkmcnt(4)
    v_mfma_f32_32x32x16_bf16 a[96:111], a[128:131], v[128:131], a[96:111]
    ds_read_b64_tr_b16 a[144:145], v192 offset:4096
    ds_read_b64_tr_b16 a[146:147], v192 offset:5120
    ds_read_b64_tr_b16 a[148:149], v193 offset:4096
    v_mfma_f32_32x32x16_bf16 a[112:127], a[132:135], v[128:131], a[112:127]
    ds_read_b64_tr_b16 a[150:151], v193 offset:5120
    ds_read_b64_tr_b16 a[152:153], v192 offset:6144
    ds_read_b64_tr_b16 a[154:155], v192 offset:7168
    s_waitcnt lgkmcnt(6)
    v_mfma_f32_32x32x16_bf16 a[96:111], a[136:139], v[132:135], a[96:111]
    ds_read_b64_tr_b16 a[156:157], v193 offset:6144
    ds_read_b64_tr_b16 a[158:159], v193 offset:7168
    buffer_load_dwordx4 v[128:131], v223, s[28:31], s59 offen offset:0 sc1
    v_mfma_f32_32x32x16_bf16 a[112:127], a[140:143], v[132:135], a[112:127]
    buffer_load_dwordx4 v219, s[20:23], s55 offen offset:0 lds
    buffer_load_dwordx4 v[132:135], v223, s[28:31], s59 offen offset:1024 sc1
    s_waitcnt vmcnt(23) lgkmcnt(4)
    v_mfma_f32_32x32x16_bf16 a[96:111], a[144:147], v[136:139], a[96:111]
    ds_read_b64_tr_b16 a[128:129], v192 offset:8192
    ds_read_b64_tr_b16 a[130:131], v192 offset:9216
    ds_read_b64_tr_b16 a[132:133], v193 offset:8192
    v_mfma_f32_32x32x16_bf16 a[112:127], a[148:151], v[136:139], a[112:127]
    ds_read_b64_tr_b16 a[134:135], v193 offset:9216
    ds_read_b64_tr_b16 a[136:137], v192 offset:10240
    ds_read_b64_tr_b16 a[138:139], v192 offset:11264
    s_waitcnt lgkmcnt(6)
    v_mfma_f32_32x32x16_bf16 a[96:111], a[152:155], v[140:143], a[96:111]
    ds_read_b64_tr_b16 a[140:141], v193 offset:10240
    ds_read_b64_tr_b16 a[142:143], v193 offset:11264
    buffer_load_dwordx4 v[136:139], v223, s[28:31], s59 offen offset:2048 sc1
    v_mfma_f32_32x32x16_bf16 a[112:127], a[156:159], v[140:143], a[112:127]
    buffer_load_dwordx4 v220, s[20:23], s55 offen offset:1024 lds
    buffer_load_dwordx4 v[140:143], v223, s[28:31], s59 offen offset:3072 sc1
    s_waitcnt vmcnt(24) lgkmcnt(4)
    v_mfma_f32_32x32x16_bf16 a[96:111], a[128:131], v[144:147], a[96:111]
    ds_read_b64_tr_b16 a[144:145], v192 offset:12288
    ds_read_b64_tr_b16 a[146:147], v192 offset:13312
    ds_read_b64_tr_b16 a[148:149], v193 offset:12288
    v_mfma_f32_32x32x16_bf16 a[112:127], a[132:135], v[144:147], a[112:127]
    ds_read_b64_tr_b16 a[150:151], v193 offset:13312
    ds_read_b64_tr_b16 a[152:153], v192 offset:14336
    ds_read_b64_tr_b16 a[154:155], v192 offset:15360
    s_waitcnt lgkmcnt(6)
    v_mfma_f32_32x32x16_bf16 a[96:111], a[136:139], v[148:151], a[96:111]
    ds_read_b64_tr_b16 a[156:157], v193 offset:14336
    ds_read_b64_tr_b16 a[158:159], v193 offset:15360
    buffer_load_dwordx4 v[144:147], v224, s[28:31], s59 offen offset:0 sc1
    v_mfma_f32_32x32x16_bf16 a[112:127], a[140:143], v[148:151], a[112:127]
    buffer_load_dwordx4 v221, s[20:23], s55 offen offset:2048 lds
    buffer_load_dwordx4 v[148:151], v224, s[28:31], s59 offen offset:1024 sc1
    s_waitcnt vmcnt(25) lgkmcnt(4)
    v_mfma_f32_32x32x16_bf16 a[96:111], a[144:147], v[152:155], a[96:111]
    ds_read_b64_tr_b16 a[128:129], v192 offset:16384
    ds_read_b64_tr_b16 a[130:131], v192 offset:17408
    ds_read_b64_tr_b16 a[132:133], v193 offset:16384
    v_mfma_f32_32x32x16_bf16 a[112:127], a[148:151], v[152:155], a[112:127]
    ds_read_b64_tr_b16 a[134:135], v193 offset:17408
    ds_read_b64_tr_b16 a[136:137], v192 offset:18432
    ds_read_b64_tr_b16 a[138:139], v192 offset:19456
    s_waitcnt lgkmcnt(6)
    v_mfma_f32_32x32x16_bf16 a[96:111], a[152:155], v[156:159], a[96:111]
    ds_read_b64_tr_b16 a[140:141], v193 offset:18432
    ds_read_b64_tr_b16 a[142:143], v193 offset:19456
    buffer_load_dwordx4 v[152:155], v224, s[28:31], s59 offen offset:2048 sc1
    v_mfma_f32_32x32x16_bf16 a[112:127], a[156:159], v[156:159], a[112:127]
    buffer_load_dwordx4 v222, s[20:23], s55 offen offset:3072 lds
    buffer_load_dwordx4 v[156:159], v224, s[28:31], s59 offen offset:3072 sc1
    s_add_u32 m0, m0, 0x4000
    s_waitcnt vmcnt(26) lgkmcnt(4)
    v_mfma_f32_32x32x16_bf16 a[96:111], a[128:131], v[160:163], a[96:111]
    ds_read_b64_tr_b16 a[144:145], v192 offset:20480
    ds_read_b64_tr_b16 a[146:147], v192 offset:21504
    ds_read_b64_tr_b16 a[148:149], v193 offset:20480
    v_mfma_f32_32x32x16_bf16 a[112:127], a[132:135], v[160:163], a[112:127]
    ds_read_b64_tr_b16 a[150:151], v193 offset:21504
    ds_read_b64_tr_b16 a[152:153], v192 offset:22528
    ds_read_b64_tr_b16 a[154:155], v192 offset:23552
    s_waitcnt lgkmcnt(6)
    v_mfma_f32_32x32x16_bf16 a[96:111], a[136:139], v[164:167], a[96:111]
    ds_read_b64_tr_b16 a[156:157], v193 offset:22528
    ds_read_b64_tr_b16 a[158:159], v193 offset:23552
    buffer_load_dwordx4 v[160:163], v223, s[28:31], s60 offen offset:0 sc1
    v_mfma_f32_32x32x16_bf16 a[112:127], a[140:143], v[164:167], a[112:127]
    buffer_load_dwordx4 v219, s[20:23], s56 offen offset:0 lds
    buffer_load_dwordx4 v[164:167], v223, s[28:31], s60 offen offset:1024 sc1
    s_waitcnt vmcnt(27) lgkmcnt(4)
    v_mfma_f32_32x32x16_bf16 a[96:111], a[144:147], v[168:171], a[96:111]
    ds_read_b64_tr_b16 a[128:129], v192 offset:24576
    ds_read_b64_tr_b16 a[130:131], v192 offset:25600
    ds_read_b64_tr_b16 a[132:133], v193 offset:24576
    v_mfma_f32_32x32x16_bf16 a[112:127], a[148:151], v[168:171], a[112:127]
    ds_read_b64_tr_b16 a[134:135], v193 offset:25600
    ds_read_b64_tr_b16 a[136:137], v192 offset:26624
    ds_read_b64_tr_b16 a[138:139], v192 offset:27648
    s_waitcnt lgkmcnt(6)
    v_mfma_f32_32x32x16_bf16 a[96:111], a[152:155], v[172:175], a[96:111]
    ds_read_b64_tr_b16 a[140:141], v193 offset:26624
    ds_read_b64_tr_b16 a[142:143], v193 offset:27648
    buffer_load_dwordx4 v[168:171], v223, s[28:31], s60 offen offset:2048 sc1
    v_mfma_f32_32x32x16_bf16 a[112:127], a[156:159], v[172:175], a[112:127]
    buffer_load_dwordx4 v220, s[20:23], s56 offen offset:1024 lds
    buffer_load_dwordx4 v[172:175], v223, s[28:31], s60 offen offset:3072 sc1
    s_waitcnt vmcnt(28) lgkmcnt(4)
    v_mfma_f32_32x32x16_bf16 a[96:111], a[128:131], v[176:179], a[96:111]
    ds_read_b64_tr_b16 a[144:145], v192 offset:28672
    ds_read_b64_tr_b16 a[146:147], v192 offset:29696
    ds_read_b64_tr_b16 a[148:149], v193 offset:28672
    v_mfma_f32_32x32x16_bf16 a[112:127], a[132:135], v[176:179], a[112:127]
    ds_read_b64_tr_b16 a[150:151], v193 offset:29696
    ds_read_b64_tr_b16 a[152:153], v192 offset:30720
    ds_read_b64_tr_b16 a[154:155], v192 offset:31744
    s_waitcnt lgkmcnt(6)
    v_mfma_f32_32x32x16_bf16 a[96:111], a[136:139], v[180:183], a[96:111]
    ds_read_b64_tr_b16 a[156:157], v193 offset:30720
    ds_read_b64_tr_b16 a[158:159], v193 offset:31744
    buffer_load_dwordx4 v[176:179], v224, s[28:31], s60 offen offset:0 sc1
    v_mfma_f32_32x32x16_bf16 a[112:127], a[140:143], v[180:183], a[112:127]
    buffer_load_dwordx4 v221, s[20:23], s56 offen offset:2048 lds
    buffer_load_dwordx4 v[180:183], v224, s[28:31], s60 offen offset:1024 sc1
    s_waitcnt vmcnt(29) lgkmcnt(4)
    v_mfma_f32_32x32x16_bf16 a[96:111], a[144:147], v[184:187], a[96:111]
    s_add_u32 s46, s45, s44
    s_add_u32 s45, s45, 0x8000
    s_cmp_eq_u32 s45, s76
    s_cselect_b32 s45, 0, s45
    v_mfma_f32_32x32x16_bf16 a[112:127], a[148:151], v[184:187], a[112:127]
    s_waitcnt lgkmcnt(0)
    v_mfma_f32_32x32x16_bf16 a[96:111], a[152:155], v[188:191], a[96:111]
    buffer_load_dwordx4 v[184:187], v224, s[28:31], s60 offen offset:2048 sc1
    v_mfma_f32_32x32x16_bf16 a[112:127], a[156:159], v[188:191], a[112:127]
    buffer_load_dwordx4 v222, s[20:23], s56 offen offset:3072 lds
    buffer_load_dwordx4 v[188:191], v224, s[28:31], s60 offen offset:3072 sc1
    s_add_u32 s54, s54, 0x100000
    s_xor_b32 s55, s54, s57
    s_add_u32 s56, s55, 0x80000
    s_add_u32 s61, s61, 0x20000
    s_xor_b32 s59, s61, s62
    s_add_u32 s60, s59, 0x10000
    s_mov_b32 m0, s46
    s_waitcnt vmcnt(56) lgkmcnt(0)
    v_mfma_f32_32x32x16_bf16 v[0:15], a[64:67], v[96:99], v[0:15]
    s_barrier
    v_add_u32 v192, s45, v204
    v_xor_b32 v193, 32, v192
    v_xor_b32 v194, 64, v192
    v_xor_b32 v195, 96, v192
    v_mfma_f32_32x32x16_bf16 v[16:31], a[68:71], v[96:99], v[16:31]
    ds_read_b128 a[32:35], v192 offset:0
    ds_read_b128 a[36:39], v193 offset:0
    v_xor_b32 v196, 128, v192
    v_xor_b32 v197, 160, v192
    v_exp_f32 v232, v80
    v_mfma_f32_32x32x16_bf16 v[32:47], a[72:75], v[96:99], v[32:47]
    ds_read_b128 a[40:43], v194 offset:0
    ds_read_b128 a[44:47], v195 offset:0
    v_xor_b32 v198, 192, v192
    v_xor_b32 v199, 224, v192
    v_exp_f32 v233, v81
    v_mfma_f32_32x32x16_bf16 v[48:63], a[76:79], v[96:99], v[48:63]
    ds_read_b128 a[48:51], v196 offset:0
    ds_read_b128 a[52:55], v197 offset:0
    v_exp_f32 v234, v82
    v_cvt_pk_bf16_f32 v104, v232, v233
    v_mfma_f32_32x32x16_bf16 v[0:15], a[80:83], v[100:103], v[0:15]
    ds_read_b128 a[56:59], v198 offset:0
    ds_read_b128 a[60:63], v199 offset:0
    v_exp_f32 v235, v83
    v_exp_f32 v232, v84
    v_mfma_f32_16x16x32_bf16 v[228:231], a[168:171], v[96:99], v[228:231]
    v_add_u32 v200, s45, v205
    v_xor_b32 v201, 64, v200
    v_mfma_f32_32x32x16_bf16 v[16:31], a[84:87], v[100:103], v[16:31]
    buffer_load_dwordx4 v209, s[12:15], s48 offen offset:0 nt lds
    v_cvt_pk_bf16_f32 v105, v234, v235
    v_exp_f32 v233, v85
    v_mfma_f32_32x32x16_bf16 v[32:47], a[88:91], v[100:103], v[32:47]
    v_exp_f32 v234, v86
    v_cvt_pk_bf16_f32 v106, v232, v233
    v_exp_f32 v235, v87
    v_or3_b32 v226, v104, v105, v106
    v_mfma_f32_16x16x32_bf16 v[228:231], a[168:171], v[100:103], v[228:231]
    v_xor_b32 v202, 128, v200
    v_xor_b32 v203, 192, v200
    v_mfma_f32_32x32x16_bf16 v[48:63], a[92:95], v[100:103], v[48:63]
    buffer_load_dwordx4 v209, s[12:15], s48 offen offset:1024 nt lds
    v_exp_f32 v232, v88
    v_cvt_pk_bf16_f32 v107, v234, v235
    s_waitcnt lgkmcnt(0)
    v_mfma_f32_32x32x16_bf16 v[64:79], a[32:35], a[0:3], v[112:127]
    ds_read_b64_tr_b16 a[64:65], v200 offset:18432
    ds_read_b64_tr_b16 a[66:67], v200 offset:22528
    ds_read_b64_tr_b16 a[68:69], v201 offset:18432
    v_exp_f32 v233, v89
    v_mfma_f32_32x32x16_bf16 v[64:79], a[36:39], a[4:7], v[64:79]
    ds_read_b64_tr_b16 a[70:71], v201 offset:22528
    ds_read_b64_tr_b16 a[72:73], v202 offset:18432
    ds_read_b64_tr_b16 a[74:75], v202 offset:22528
    v_exp_f32 v234, v90
    v_cvt_pk_bf16_f32 v108, v232, v233
    v_mfma_f32_32x32x16_bf16 v[64:79], a[40:43], a[8:11], v[64:79]
    ds_read_b64_tr_b16 a[76:77], v203 offset:18432
    ds_read_b64_tr_b16 a[78:79], v203 offset:22528
    ds_read_b64_tr_b16 a[80:81], v200 offset:26624
    v_exp_f32 v235, v91
    v_or3_b32 v226, v226, v107, v108
    v_mfma_f32_32x32x16_bf16 v[64:79], a[44:47], a[12:15], v[64:79]
    ds_read_b64_tr_b16 a[82:83], v200 offset:30720
    ds_read_b64_tr_b16 a[84:85], v201 offset:26624
    ds_read_b64_tr_b16 a[86:87], v201 offset:30720
    v_exp_f32 v232, v92
    v_cvt_pk_bf16_f32 v109, v234, v235
    v_mfma_f32_32x32x16_bf16 v[64:79], a[48:51], a[16:19], v[64:79]
    ds_read_b64_tr_b16 a[88:89], v202 offset:26624
    ds_read_b64_tr_b16 a[90:91], v202 offset:30720
    v_exp_f32 v233, v93
    v_mfma_f32_32x32x16_bf16 v[64:79], a[52:55], a[20:23], v[64:79]
    ds_read_b64_tr_b16 a[92:93], v203 offset:26624
    ds_read_b64_tr_b16 a[94:95], v203 offset:30720
    buffer_load_dwordx4 v209, s[12:15], s48 offen offset:2048 nt lds
    v_exp_f32 v234, v94
    v_cvt_pk_bf16_f32 v110, v232, v233
    v_mfma_f32_32x32x16_bf16 v[64:79], a[56:59], a[24:27], v[64:79]
    v_exp_f32 v235, v95
    v_or3_b32 v226, v226, v109, v110
    v_cvt_pk_bf16_f32 v111, v234, v235
    v_bitop3_b32 v226, v226, s65, v111 bitop3:0xc8
    v_cmp_ne_u32 vcc, 0, v226
    v_mfma_f32_32x32x16_bf16 v[64:79], a[60:63], a[28:31], v[64:79]
    buffer_load_dwordx4 v209, s[12:15], s48 offen offset:3072 nt lds
    s_cbranch_vccnz Ltr_17
Lbk_18:
    s_waitcnt lgkmcnt(0)
    v_mfma_f32_32x32x16_bf16 v[0:15], a[64:67], v[104:107], v[0:15]
    ds_read_b128 a[32:35], v192 offset:2048
    ds_read_b128 a[36:39], v193 offset:2048
    s_add_u32 m0, m0, 0x4000
    v_mfma_f32_32x32x16_bf16 v[16:31], a[68:71], v[104:107], v[16:31]
    ds_read_b128 a[40:43], v194 offset:2048
    ds_read_b128 a[44:47], v195 offset:2048
    v_exp_f32 v232, v64
    v_mfma_f32_32x32x16_bf16 v[32:47], a[72:75], v[104:107], v[32:47]
    ds_read_b128 a[48:51], v196 offset:2048
    ds_read_b128 a[52:55], v197 offset:2048
    v_exp_f32 v233, v65
    v_exp_f32 v234, v66
    v_mfma_f32_32x32x16_bf16 v[48:63], a[76:79], v[104:107], v[48:63]
    ds_read_b128 a[56:59], v198 offset:2048
    ds_read_b128 a[60:63], v199 offset:2048
    v_cvt_pk_bf16_f32 v96, v232, v233
    v_exp_f32 v235, v67
    v_mfma_f32_32x32x16_bf16 v[0:15], a[80:83], v[108:111], v[0:15]
    v_exp_f32 v232, v68
    v_cvt_pk_bf16_f32 v97, v234, v235
    v_exp_f32 v233, v69
    v_mfma_f32_16x16x32_bf16 v[228:231], a[168:171], v[104:107], v[228:231]
    s_add_u32 s46, s45, s44
    s_add_u32 s45, s45, 0x8000
    v_mfma_f32_32x32x16_bf16 v[16:31], a[84:87], v[108:111], v[16:31]
    buffer_load_dwordx4 v210, s[16:19], s48 offen offset:0 nt lds
    v_exp_f32 v234, v70
    v_cvt_pk_bf16_f32 v98, v232, v233
    v_mfma_f32_32x32x16_bf16 v[32:47], a[88:91], v[108:111], v[32:47]
    v_exp_f32 v235, v71
    v_or3_b32 v226, v96, v97, v98
    v_exp_f32 v232, v72
    v_cvt_pk_bf16_f32 v99, v234, v235
    v_mfma_f32_16x16x32_bf16 v[228:231], a[168:171], v[108:111], v[228:231]
    s_cmp_eq_u32 s45, s76
    s_cselect_b32 s45, 0, s45
    v_mfma_f32_32x32x16_bf16 v[48:63], a[92:95], v[108:111], v[48:63]
    buffer_load_dwordx4 v210, s[16:19], s48 offen offset:1024 nt lds
    v_exp_f32 v233, v73
    s_waitcnt lgkmcnt(0)
    v_mfma_f32_32x32x16_bf16 v[80:95], a[32:35], a[0:3], v[112:127]
    ds_read_b64_tr_b16 a[64:65], v200 offset:16384
    ds_read_b64_tr_b16 a[66:67], v200 offset:20480
    ds_read_b64_tr_b16 a[68:69], v201 offset:16384
    v_exp_f32 v234, v74
    v_cvt_pk_bf16_f32 v100, v232, v233
    v_mfma_f32_32x32x16_bf16 v[80:95], a[36:39], a[4:7], v[80:95]
    ds_read_b64_tr_b16 a[70:71], v201 offset:20480
    ds_read_b64_tr_b16 a[72:73], v202 offset:16384
    ds_read_b64_tr_b16 a[74:75], v202 offset:20480
    v_exp_f32 v235, v75
    v_or3_b32 v226, v226, v99, v100
    v_mfma_f32_32x32x16_bf16 v[80:95], a[40:43], a[8:11], v[80:95]
    ds_read_b64_tr_b16 a[76:77], v203 offset:16384
    ds_read_b64_tr_b16 a[78:79], v203 offset:20480
    ds_read_b64_tr_b16 a[80:81], v200 offset:24576
    v_exp_f32 v232, v76
    v_mfma_f32_32x32x16_bf16 v[80:95], a[44:47], a[12:15], v[80:95]
    ds_read_b64_tr_b16 a[82:83], v200 offset:28672
    ds_read_b64_tr_b16 a[84:85], v201 offset:24576
    ds_read_b64_tr_b16 a[86:87], v201 offset:28672
    v_cvt_pk_bf16_f32 v101, v234, v235
    v_mfma_f32_32x32x16_bf16 v[80:95], a[48:51], a[16:19], v[80:95]
    ds_read_b64_tr_b16 a[88:89], v202 offset:24576
    ds_read_b64_tr_b16 a[90:91], v202 offset:28672
    v_exp_f32 v233, v77
    v_exp_f32 v234, v78
    v_mfma_f32_32x32x16_bf16 v[80:95], a[52:55], a[20:23], v[80:95]
    ds_read_b64_tr_b16 a[92:93], v203 offset:24576
    ds_read_b64_tr_b16 a[94:95], v203 offset:28672
    buffer_load_dwordx4 v210, s[16:19], s49 offen offset:2048 nt lds
    v_cvt_pk_bf16_f32 v102, v232, v233
    v_exp_f32 v235, v79
    v_mfma_f32_32x32x16_bf16 v[80:95], a[56:59], a[24:27], v[80:95]
    v_or3_b32 v226, v226, v101, v102
    v_cvt_pk_bf16_f32 v103, v234, v235
    v_bitop3_b32 v226, v226, s64, v103 bitop3:0xc8
    v_cmp_ne_u32 vcc, s63, v226
    v_mfma_f32_32x32x16_bf16 v[80:95], a[60:63], a[28:31], v[80:95]
    buffer_load_dwordx4 v210, s[16:19], s49 offen offset:3072 nt lds
    s_mov_b32 s49, s48
    s_add_u32 s48, s48, 0x4000
    s_mov_b32 m0, s46
    s_sub_u32 s47, s47, 1
    s_cbranch_vccnz Ltr_19
Lbk_20:
    s_cbranch_scc0 Llp_16
    v_add_u32 v192, s45, v208
    v_xor_b32 v193, 64, v192
    s_waitcnt vmcnt(41) lgkmcnt(0)
    s_barrier
    ds_read_b64_tr_b16 a[128:129], v192 offset:0
    ds_read_b64_tr_b16 a[130:131], v192 offset:1024
    ds_read_b64_tr_b16 a[132:133], v193 offset:0
    ds_read_b64_tr_b16 a[134:135], v193 offset:1024
    ds_read_b64_tr_b16 a[136:137], v192 offset:2048
    ds_read_b64_tr_b16 a[138:139], v192 offset:3072
    ds_read_b64_tr_b16 a[140:141], v193 offset:2048
    ds_read_b64_tr_b16 a[142:143], v193 offset:3072
    s_waitcnt vmcnt(29) lgkmcnt(4)
    v_mfma_f32_32x32x16_bf16 a[96:111], a[128:131], v[128:131], a[96:111]
    ds_read_b64_tr_b16 a[144:145], v192 offset:4096
    ds_read_b64_tr_b16 a[146:147], v192 offset:5120
    ds_read_b64_tr_b16 a[148:149], v193 offset:4096
    v_mfma_f32_32x32x16_bf16 a[112:127], a[132:135], v[128:131], a[112:127]
    ds_read_b64_tr_b16 a[150:151], v193 offset:5120
    ds_read_b64_tr_b16 a[152:153], v192 offset:6144
    ds_read_b64_tr_b16 a[154:155], v192 offset:7168
    s_waitcnt lgkmcnt(6)
    v_mfma_f32_32x32x16_bf16 a[96:111], a[136:139], v[132:135], a[96:111]
    ds_read_b64_tr_b16 a[156:157], v193 offset:6144
    ds_read_b64_tr_b16 a[158:159], v193 offset:7168
    buffer_load_dwordx4 v[128:131], v223, s[28:31], s59 offen offset:0 sc1
    v_mfma_f32_32x32x16_bf16 a[112:127], a[140:143], v[132:135], a[112:127]
    buffer_load_dwordx4 v[132:135], v223, s[28:31], s59 offen offset:1024 sc1
    s_waitcnt vmcnt(28) lgkmcnt(4)
    v_mfma_f32_32x32x16_bf16 a[96:111], a[144:147], v[136:139], a[96:111]
    ds_read_b64_tr_b16 a[128:129], v192 offset:8192
    ds_read_b64_tr_b16 a[130:131], v192 offset:9216
    ds_read_b64_tr_b16 a[132:133], v193 offset:8192
    v_mfma_f32_32x32x16_bf16 a[112:127], a[148:151], v[136:139], a[112:127]
    ds_read_b64_tr_b16 a[134:135], v193 offset:9216
    ds_read_b64_tr_b16 a[136:137], v192 offset:10240
    ds_read_b64_tr_b16 a[138:139], v192 offset:11264
    s_waitcnt lgkmcnt(6)
    v_mfma_f32_32x32x16_bf16 a[96:111], a[152:155], v[140:143], a[96:111]
    ds_read_b64_tr_b16 a[140:141], v193 offset:10240
    ds_read_b64_tr_b16 a[142:143], v193 offset:11264
    buffer_load_dwordx4 v[136:139], v223, s[28:31], s59 offen offset:2048 sc1
    v_mfma_f32_32x32x16_bf16 a[112:127], a[156:159], v[140:143], a[112:127]
    buffer_load_dwordx4 v[140:143], v223, s[28:31], s59 offen offset:3072 sc1
    s_waitcnt vmcnt(27) lgkmcnt(4)
    v_mfma_f32_32x32x16_bf16 a[96:111], a[128:131], v[144:147], a[96:111]
    ds_read_b64_tr_b16 a[144:145], v192 offset:12288
    ds_read_b64_tr_b16 a[146:147], v192 offset:13312
    ds_read_b64_tr_b16 a[148:149], v193 offset:12288
    v_mfma_f32_32x32x16_bf16 a[112:127], a[132:135], v[144:147], a[112:127]
    ds_read_b64_tr_b16 a[150:151], v193 offset:13312
    ds_read_b64_tr_b16 a[152:153], v192 offset:14336
    ds_read_b64_tr_b16 a[154:155], v192 offset:15360
    s_waitcnt lgkmcnt(6)
    v_mfma_f32_32x32x16_bf16 a[96:111], a[136:139], v[148:151], a[96:111]
    ds_read_b64_tr_b16 a[156:157], v193 offset:14336
    ds_read_b64_tr_b16 a[158:159], v193 offset:15360
    buffer_load_dwordx4 v[144:147], v224, s[28:31], s59 offen offset:0 sc1
    v_mfma_f32_32x32x16_bf16 a[112:127], a[140:143], v[148:151], a[112:127]
    buffer_load_dwordx4 v[148:151], v224, s[28:31], s59 offen offset:1024 sc1
    s_waitcnt vmcnt(26) lgkmcnt(4)
    v_mfma_f32_32x32x16_bf16 a[96:111], a[144:147], v[152:155], a[96:111]
    ds_read_b64_tr_b16 a[128:129], v192 offset:16384
    ds_read_b64_tr_b16 a[130:131], v192 offset:17408
    ds_read_b64_tr_b16 a[132:133], v193 offset:16384
    v_mfma_f32_32x32x16_bf16 a[112:127], a[148:151], v[152:155], a[112:127]
    ds_read_b64_tr_b16 a[134:135], v193 offset:17408
    ds_read_b64_tr_b16 a[136:137], v192 offset:18432
    ds_read_b64_tr_b16 a[138:139], v192 offset:19456
    s_waitcnt lgkmcnt(6)
    v_mfma_f32_32x32x16_bf16 a[96:111], a[152:155], v[156:159], a[96:111]
    ds_read_b64_tr_b16 a[140:141], v193 offset:18432
    ds_read_b64_tr_b16 a[142:143], v193 offset:19456
    buffer_load_dwordx4 v[152:155], v224, s[28:31], s59 offen offset:2048 sc1
    v_mfma_f32_32x32x16_bf16 a[112:127], a[156:159], v[156:159], a[112:127]
    buffer_load_dwordx4 v[156:159], v224, s[28:31], s59 offen offset:3072 sc1
    s_waitcnt vmcnt(25) lgkmcnt(4)
    v_mfma_f32_32x32x16_bf16 a[96:111], a[128:131], v[160:163], a[96:111]
    ds_read_b64_tr_b16 a[144:145], v192 offset:20480
    ds_read_b64_tr_b16 a[146:147], v192 offset:21504
    ds_read_b64_tr_b16 a[148:149], v193 offset:20480
    v_mfma_f32_32x32x16_bf16 a[112:127], a[132:135], v[160:163], a[112:127]
    ds_read_b64_tr_b16 a[150:151], v193 offset:21504
    ds_read_b64_tr_b16 a[152:153], v192 offset:22528
    ds_read_b64_tr_b16 a[154:155], v192 offset:23552
    s_waitcnt lgkmcnt(6)
    v_mfma_f32_32x32x16_bf16 a[96:111], a[136:139], v[164:167], a[96:111]
    ds_read_b64_tr_b16 a[156:157], v193 offset:22528
    ds_read_b64_tr_b16 a[158:159], v193 offset:23552
    buffer_load_dwordx4 v[160:163], v223, s[28:31], s60 offen offset:0 sc1
    v_mfma_f32_32x32x16_bf16 a[112:127], a[140:143], v[164:167], a[112:127]
    buffer_load_dwordx4 v[164:167], v223, s[28:31], s60 offen offset:1024 sc1
    s_waitcnt vmcnt(24) lgkmcnt(4)
    v_mfma_f32_32x32x16_bf16 a[96:111], a[144:147], v[168:171], a[96:111]
    ds_read_b64_tr_b16 a[128:129], v192 offset:24576
    ds_read_b64_tr_b16 a[130:131], v192 offset:25600
    ds_read_b64_tr_b16 a[132:133], v193 offset:24576
    v_mfma_f32_32x32x16_bf16 a[112:127], a[148:151], v[168:171], a[112:127]
    ds_read_b64_tr_b16 a[134:135], v193 offset:25600
    ds_read_b64_tr_b16 a[136:137], v192 offset:26624
    ds_read_b64_tr_b16 a[138:139], v192 offset:27648
    s_waitcnt lgkmcnt(6)
    v_mfma_f32_32x32x16_bf16 a[96:111], a[152:155], v[172:175], a[96:111]
    ds_read_b64_tr_b16 a[140:141], v193 offset:26624
    ds_read_b64_tr_b16 a[142:143], v193 offset:27648
    buffer_load_dwordx4 v[168:171], v223, s[28:31], s60 offen offset:2048 sc1
    v_mfma_f32_32x32x16_bf16 a[112:127], a[156:159], v[172:175], a[112:127]
    buffer_load_dwordx4 v[172:175], v223, s[28:31], s60 offen offset:3072 sc1
    s_waitcnt vmcnt(23) lgkmcnt(4)
    v_mfma_f32_32x32x16_bf16 a[96:111], a[128:131], v[176:179], a[96:111]
    ds_read_b64_tr_b16 a[144:145], v192 offset:28672
    ds_read_b64_tr_b16 a[146:147], v192 offset:29696
    ds_read_b64_tr_b16 a[148:149], v193 offset:28672
    v_mfma_f32_32x32x16_bf16 a[112:127], a[132:135], v[176:179], a[112:127]
    ds_read_b64_tr_b16 a[150:151], v193 offset:29696
    ds_read_b64_tr_b16 a[152:153], v192 offset:30720
    ds_read_b64_tr_b16 a[154:155], v192 offset:31744
    s_waitcnt lgkmcnt(6)
    v_mfma_f32_32x32x16_bf16 a[96:111], a[136:139], v[180:183], a[96:111]
    ds_read_b64_tr_b16 a[156:157], v193 offset:30720
    ds_read_b64_tr_b16 a[158:159], v193 offset:31744
    buffer_load_dwordx4 v[176:179], v224, s[28:31], s60 offen offset:0 sc1
    v_mfma_f32_32x32x16_bf16 a[112:127], a[140:143], v[180:183], a[112:127]
    buffer_load_dwordx4 v[180:183], v224, s[28:31], s60 offen offset:1024 sc1
    s_waitcnt vmcnt(22) lgkmcnt(4)
    v_mfma_f32_32x32x16_bf16 a[96:111], a[144:147], v[184:187], a[96:111]
    buffer_load_dwordx4 v209, s[12:15], s48 offen offset:0 nt lds
    buffer_load_dwordx4 v209, s[12:15], s48 offen offset:1024 nt lds
    buffer_load_dwordx4 v209, s[12:15], s48 offen offset:2048 nt lds
    s_add_u32 s46, s45, s44
    s_add_u32 s45, s45, 0x8000
    s_cmp_eq_u32 s45, s76
    s_cselect_b32 s45, 0, s45
    v_mfma_f32_32x32x16_bf16 a[112:127], a[148:151], v[184:187], a[112:127]
    buffer_load_dwordx4 v209, s[12:15], s48 offen offset:3072 nt lds
    s_waitcnt lgkmcnt(0)
    s_add_u32 m0, m0, 0x4000
    v_mfma_f32_32x32x16_bf16 a[96:111], a[152:155], v[188:191], a[96:111]
    buffer_load_dwordx4 v[184:187], v224, s[28:31], s60 offen offset:2048 sc1
    buffer_load_dwordx4 v210, s[16:19], s48 offen offset:0 nt lds
    buffer_load_dwordx4 v210, s[16:19], s48 offen offset:1024 nt lds
    v_mfma_f32_32x32x16_bf16 a[112:127], a[156:159], v[188:191], a[112:127]
    buffer_load_dwordx4 v[188:191], v224, s[28:31], s60 offen offset:3072 sc1
    buffer_load_dwordx4 v210, s[16:19], s49 offen offset:2048 nt lds
    buffer_load_dwordx4 v210, s[16:19], s49 offen offset:3072 nt lds
    s_mov_b32 s49, s48
    s_add_u32 s48, s48, 0x4000
    s_add_u32 s61, s61, 0x20000
    s_xor_b32 s59, s61, s62
    s_add_u32 s60, s59, 0x10000
    s_mov_b32 m0, s46
    s_lshl_b32 s55, s71, 20
    s_add_u32 s55, s55, 0x40000
    s_add_u32 s56, s55, 0x80000
    s_mov_b32 s57, s55
    s_mov_b32 s54, 0
    s_mov_b32 s47, 0
    s_call_b64 s[40:41], LAP7
    s_mov_b32 s47, 0
    s_call_b64 s[40:41], LPP4
    s_mov_b32 s47, 0
    s_call_b64 s[40:41], LAP7
    s_waitcnt vmcnt(40)
    s_call_b64 s[40:41], LE
    buffer_load_dwordx4 v219, s[20:23], s55 offen offset:0 lds
    buffer_load_dwordx4 v220, s[20:23], s55 offen offset:1024 lds
    buffer_load_dwordx4 v221, s[20:23], s55 offen offset:2048 lds
    buffer_load_dwordx4 v222, s[20:23], s55 offen offset:3072 lds
    s_add_u32 m0, m0, 0x4000
    s_nop 0
    buffer_load_dwordx4 v219, s[20:23], s56 offen offset:0 lds
    buffer_load_dwordx4 v220, s[20:23], s56 offen offset:1024 lds
    buffer_load_dwordx4 v221, s[20:23], s56 offen offset:2048 lds
    buffer_load_dwordx4 v222, s[20:23], s56 offen offset:3072 lds
    s_add_u32 s54, s54, 0x100000
    s_xor_b32 s55, s54, s57
    s_add_u32 s56, s55, 0x80000
    s_add_u32 m0, s45, s44
    s_add_u32 s45, s45, 0x8000
    s_cmp_eq_u32 s45, s76
    s_cselect_b32 s45, 0, s45
    s_waitcnt vmcnt(8)
    s_barrier
    s_cmp_lg_u32 s67, 0
    s_cbranch_scc1 Lsg_21
    v_mov_b32 v236, 1
    s_mov_b64 exec, 1
    buffer_store_dword v236, off, s[96:99], s100 offset:2176 sc1
    s_mov_b64 exec, -1
Lsg_21:
    buffer_load_dwordx4 v219, s[20:23], s55 offen offset:0 lds
    buffer_load_dwordx4 v220, s[20:23], s55 offen offset:1024 lds
    buffer_load_dwordx4 v221, s[20:23], s55 offen offset:2048 lds
    buffer_load_dwordx4 v222, s[20:23], s55 offen offset:3072 lds
    s_add_u32 m0, m0, 0x4000
    s_nop 0
    buffer_load_dwordx4 v219, s[20:23], s56 offen offset:0 lds
    buffer_load_dwordx4 v220, s[20:23], s56 offen offset:1024 lds
    buffer_load_dwordx4 v221, s[20:23], s56 offen offset:2048 lds
    buffer_load_dwordx4 v222, s[20:23], s56 offen offset:3072 lds
    s_add_u32 s54, s54, 0x100000
    s_xor_b32 s55, s54, s57
    s_add_u32 s56, s55, 0x80000
    v_mbcnt_lo_u32_b32 v237, -1, 0
    v_mbcnt_hi_u32_b32 v237, -1, v237
    v_lshlrev_b32 v237, 4, v237
    buffer_load_dwordx4 a[0:3], v219, s[20:23], s55 offen offset:0
    buffer_load_dwordx4 a[4:7], v220, s[20:23], s55 offen offset:1024
    buffer_load_dwordx4 a[8:11], v221, s[20:23], s55 offen offset:2048
    buffer_load_dwordx4 a[12:15], v222, s[20:23], s55 offen offset:3072
    buffer_load_dwordx4 a[16:19], v219, s[20:23], s56 offen offset:0
    buffer_load_dwordx4 a[20:23], v220, s[20:23], s56 offen offset:1024
    buffer_load_dwordx4 a[24:27], v221, s[20:23], s56 offen offset:2048
    buffer_load_dwordx4 a[28:31], v222, s[20:23], s56 offen offset:3072
    s_add_u32 s54, s54, 0x100000
    s_xor_b32 s55, s54, s57
    s_add_u32 s56, s55, 0x80000
    buffer_load_dwordx4 a[32:35], v219, s[20:23], s55 offen offset:0
    buffer_load_dwordx4 a[36:39], v220, s[20:23], s55 offen offset:1024
    buffer_load_dwordx4 a[40:43], v221, s[20:23], s55 offen offset:2048
    buffer_load_dwordx4 a[44:47], v222, s[20:23], s55 offen offset:3072
    buffer_load_dwordx4 a[48:51], v219, s[20:23], s56 offen offset:0
    buffer_load_dwordx4 a[52:55], v220, s[20:23], s56 offen offset:1024
    buffer_load_dwordx4 a[56:59], v221, s[20:23], s56 offen offset:2048
    buffer_load_dwordx4 a[60:63], v222, s[20:23], s56 offen offset:3072
    s_add_u32 s54, s54, 0x100000
    s_xor_b32 s55, s54, s57
    s_add_u32 s56, s55, 0x80000
    buffer_load_dwordx4 a[64:67], v219, s[20:23], s55 offen offset:0
    buffer_load_dwordx4 a[68:71], v220, s[20:23], s55 offen offset:1024
    buffer_load_dwordx4 a[72:75], v221, s[20:23], s55 offen offset:2048
    buffer_load_dwordx4 a[76:79], v222, s[20:23], s55 offen offset:3072
    buffer_load_dwordx4 a[80:83], v219, s[20:23], s56 offen offset:0
    buffer_load_dwordx4 a[84:87], v220, s[20:23], s56 offen offset:1024
    buffer_load_dwordx4 a[88:91], v221, s[20:23], s56 offen offset:2048
    buffer_load_dwordx4 a[92:95], v222, s[20:23], s56 offen offset:3072
    s_add_u32 s54, s54, 0x100000
    s_xor_b32 s55, s54, s57
    s_add_u32 s56, s55, 0x80000
    s_cmp_lg_u32 s67, 0
    s_cbranch_scc1 Lpd_24
    s_mov_b32 s73, 0x20000
Lpl_22:
    buffer_load_dword v227, v255, s[96:99], s101 offen offset:2176 sc1
    s_waitcnt vmcnt(0)
Lpc_23:
    v_cmp_gt_u32 vcc, 1, v227
    s_sub_u32 s73, s73, 1
    s_cbranch_scc1 Lpd_24
    s_cbranch_vccz Lpd_24
    s_sleep 8
    s_branch Lpl_22
Lpd_24:
    s_barrier
    s_lshl_b32 s59, s71, 17
    s_add_u32 s59, s59, 0x8000
    s_add_u32 s60, s59, 0x10000
    s_mov_b32 s62, s59
    s_mov_b32 s61, 0
    buffer_load_dwordx4 v[128:131], v223, s[28:31], s59 offen offset:0 sc1
    buffer_load_dwordx4 v[132:135], v223, s[28:31], s59 offen offset:1024 sc1
    buffer_load_dwordx4 v[136:139], v223, s[28:31], s59 offen offset:2048 sc1
    buffer_load_dwordx4 v[140:143], v223, s[28:31], s59 offen offset:3072 sc1
    buffer_load_dwordx4 v[144:147], v224, s[28:31], s59 offen offset:0 sc1
    buffer_load_dwordx4 v[148:151], v224, s[28:31], s59 offen offset:1024 sc1
    buffer_load_dwordx4 v[152:155], v224, s[28:31], s59 offen offset:2048 sc1
    buffer_load_dwordx4 v[156:159], v224, s[28:31], s59 offen offset:3072 sc1
    buffer_load_dwordx4 v[160:163], v223, s[28:31], s60 offen offset:0 sc1
    buffer_load_dwordx4 v[164:167], v223, s[28:31], s60 offen offset:1024 sc1
    buffer_load_dwordx4 v[168:171], v223, s[28:31], s60 offen offset:2048 sc1
    buffer_load_dwordx4 v[172:175], v223, s[28:31], s60 offen offset:3072 sc1
    buffer_load_dwordx4 v[176:179], v224, s[28:31], s60 offen offset:0 sc1
    buffer_load_dwordx4 v[180:183], v224, s[28:31], s60 offen offset:1024 sc1
    buffer_load_dwordx4 v[184:187], v224, s[28:31], s60 offen offset:2048 sc1
    buffer_load_dwordx4 v[188:191], v224, s[28:31], s60 offen offset:3072 sc1
    s_add_u32 s61, s61, 0x20000
    s_xor_b32 s59, s61, s62
    s_add_u32 s60, s59, 0x10000
    s_mov_b32 s47, 0
    s_call_b64 s[40:41], LPN9
    s_mov_b32 s47, 2
Llp_25:
    v_add_u32 v192, s45, v208
    v_xor_b32 v193, 64, v192
    v_add_u32 v238, m0, v237
    s_waitcnt vmcnt(63) lgkmcnt(0)
    s_barrier
    ds_read_b64_tr_b16 a[128:129], v192 offset:0
    ds_read_b64_tr_b16 a[130:131], v192 offset:1024
    ds_read_b64_tr_b16 a[132:133], v193 offset:0
    ds_read_b64_tr_b16 a[134:135], v193 offset:1024
    ds_read_b64_tr_b16 a[136:137], v192 offset:2048
    ds_read_b64_tr_b16 a[138:139], v192 offset:3072
    ds_read_b64_tr_b16 a[140:141], v193 offset:2048
    ds_read_b64_tr_b16 a[142:143], v193 offset:3072
    s_waitcnt vmcnt(14) lgkmcnt(4)
    v_mfma_f32_32x32x16_bf16 a[96:111], a[128:131], v[128:131], a[96:111]
    ds_read_b64_tr_b16 a[144:145], v192 offset:4096
    ds_read_b64_tr_b16 a[146:147], v192 offset:5120
    ds_read_b64_tr_b16 a[148:149], v193 offset:4096
    v_mfma_f32_32x32x16_bf16 a[112:127], a[132:135], v[128:131], a[112:127]
    ds_read_b64_tr_b16 a[150:151], v193 offset:5120
    ds_read_b64_tr_b16 a[152:153], v192 offset:6144
    ds_read_b64_tr_b16 a[154:155], v192 offset:7168
    s_waitcnt lgkmcnt(6)
    v_mfma_f32_32x32x16_bf16 a[96:111], a[136:139], v[132:135], a[96:111]
    ds_read_b64_tr_b16 a[156:157], v193 offset:6144
    ds_read_b64_tr_b16 a[158:159], v193 offset:7168
    buffer_load_dwordx4 v[128:131], v223, s[28:31], s59 offen offset:0 sc1
    v_mfma_f32_32x32x16_bf16 a[112:127], a[140:143], v[132:135], a[112:127]
    ds_write_b128 v238, a[0:3] offset:0
    buffer_load_dwordx4 v[132:135], v223, s[28:31], s59 offen offset:1024 sc1
    s_waitcnt vmcnt(14) lgkmcnt(5)
    v_mfma_f32_32x32x16_bf16 a[96:111], a[144:147], v[136:139], a[96:111]
    ds_read_b64_tr_b16 a[128:129], v192 offset:8192
    ds_read_b64_tr_b16 a[130:131], v192 offset:9216
    ds_read_b64_tr_b16 a[132:133], v193 offset:8192
    v_mfma_f32_32x32x16_bf16 a[112:127], a[148:151], v[136:139], a[112:127]
    ds_read_b64_tr_b16 a[134:135], v193 offset:9216
    ds_read_b64_tr_b16 a[136:137], v192 offset:10240
    ds_read_b64_tr_b16 a[138:139], v192 offset:11264
    s_waitcnt lgkmcnt(6)
    v_mfma_f32_32x32x16_bf16 a[96:111], a[152:155], v[140:143], a[96:111]
    ds_read_b64_tr_b16 a[140:141], v193 offset:10240
    ds_read_b64_tr_b16 a[142:143], v193 offset:11264
    buffer_load_dwordx4 v[136:139], v223, s[28:31], s59 offen offset:2048 sc1
    v_accvgpr_mov_b32 a0, a32
    v_accvgpr_mov_b32 a1, a33
    v_accvgpr_mov_b32 a2, a34
    v_accvgpr_mov_b32 a3, a35
    v_mfma_f32_32x32x16_bf16 a[112:127], a[156:159], v[140:143], a[112:127]
    ds_write_b128 v238, a[4:7] offset:1024
    buffer_load_dwordx4 v[140:143], v223, s[28:31], s59 offen offset:3072 sc1
    v_accvgpr_mov_b32 a32, a64
    v_accvgpr_mov_b32 a33, a65
    v_accvgpr_mov_b32 a34, a66
    v_accvgpr_mov_b32 a35, a67
    s_waitcnt vmcnt(14) lgkmcnt(5)
    v_mfma_f32_32x32x16_bf16 a[96:111], a[128:131], v[144:147], a[96:111]
    ds_read_b64_tr_b16 a[144:145], v192 offset:12288
    ds_read_b64_tr_b16 a[146:147], v192 offset:13312
    ds_read_b64_tr_b16 a[148:149], v193 offset:12288
    v_mfma_f32_32x32x16_bf16 a[112:127], a[132:135], v[144:147], a[112:127]
    ds_read_b64_tr_b16 a[150:151], v193 offset:13312
    ds_read_b64_tr_b16 a[152:153], v192 offset:14336
    ds_read_b64_tr_b16 a[154:155], v192 offset:15360
    s_waitcnt lgkmcnt(6)
    v_mfma_f32_32x32x16_bf16 a[96:111], a[136:139], v[148:151], a[96:111]
    ds_read_b64_tr_b16 a[156:157], v193 offset:14336
    ds_read_b64_tr_b16 a[158:159], v193 offset:15360
    buffer_load_dwordx4 v[144:147], v224, s[28:31], s59 offen offset:0 sc1
    v_accvgpr_mov_b32 a4, a36
    v_accvgpr_mov_b32 a5, a37
    v_accvgpr_mov_b32 a6, a38
    v_accvgpr_mov_b32 a7, a39
    v_mfma_f32_32x32x16_bf16 a[112:127], a[140:143], v[148:151], a[112:127]
    ds_write_b128 v238, a[8:11] offset:2048
    buffer_load_dwordx4 v[148:151], v224, s[28:31], s59 offen offset:1024 sc1
    v_accvgpr_mov_b32 a36, a68
    v_accvgpr_mov_b32 a37, a69
    v_accvgpr_mov_b32 a38, a70
    v_accvgpr_mov_b32 a39, a71
    s_waitcnt vmcnt(14) lgkmcnt(5)
    v_mfma_f32_32x32x16_bf16 a[96:111], a[144:147], v[152:155], a[96:111]
    ds_read_b64_tr_b16 a[128:129], v192 offset:16384
    ds_read_b64_tr_b16 a[130:131], v192 offset:17408
    ds_read_b64_tr_b16 a[132:133], v193 offset:16384
    v_mfma_f32_32x32x16_bf16 a[112:127], a[148:151], v[152:155], a[112:127]
    ds_read_b64_tr_b16 a[134:135], v193 offset:17408
    ds_read_b64_tr_b16 a[136:137], v192 offset:18432
    ds_read_b64_tr_b16 a[138:139], v192 offset:19456
    s_waitcnt lgkmcnt(6)
    v_mfma_f32_32x32x16_bf16 a[96:111], a[152:155], v[156:159], a[96:111]
    ds_read_b64_tr_b16 a[140:141], v193 offset:18432
    ds_read_b64_tr_b16 a[142:143], v193 offset:19456
    buffer_load_dwordx4 v[152:155], v224, s[28:31], s59 offen offset:2048 sc1
    v_accvgpr_mov_b32 a8, a40
    v_accvgpr_mov_b32 a9, a41
    v_accvgpr_mov_b32 a10, a42
    v_accvgpr_mov_b32 a11, a43
    v_mfma_f32_32x32x16_bf16 a[112:127], a[156:159], v[156:159], a[112:127]
    ds_write_b128 v238, a[12:15] offset:3072
    buffer_load_dwordx4 v[156:159], v224, s[28:31], s59 offen offset:3072 sc1
    v_accvgpr_mov_b32 a40, a72
    v_accvgpr_mov_b32 a41, a73
    v_accvgpr_mov_b32 a42, a74
    v_accvgpr_mov_b32 a43, a75
    s_waitcnt vmcnt(14) lgkmcnt(5)
    v_mfma_f32_32x32x16_bf16 a[96:111], a[128:131], v[160:163], a[96:111]
    ds_read_b64_tr_b16 a[144:145], v192 offset:20480
    ds_read_b64_tr_b16 a[146:147], v192 offset:21504
    ds_read_b64_tr_b16 a[148:149], v193 offset:20480
    v_mfma_f32_32x32x16_bf16 a[112:127], a[132:135], v[160:163], a[112:127]
    ds_read_b64_tr_b16 a[150:151], v193 offset:21504
    ds_read_b64_tr_b16 a[152:153], v192 offset:22528
    ds_read_b64_tr_b16 a[154:155], v192 offset:23552
    s_waitcnt lgkmcnt(6)
    v_mfma_f32_32x32x16_bf16 a[96:111], a[136:139], v[164:167], a[96:111]
    ds_read_b64_tr_b16 a[156:157], v193 offset:22528
    ds_read_b64_tr_b16 a[158:159], v193 offset:23552
    buffer_load_dwordx4 v[160:163], v223, s[28:31], s60 offen offset:0 sc1
    v_accvgpr_mov_b32 a12, a44
    v_accvgpr_mov_b32 a13, a45
    v_accvgpr_mov_b32 a14, a46
    v_accvgpr_mov_b32 a15, a47
    v_mfma_f32_32x32x16_bf16 a[112:127], a[140:143], v[164:167], a[112:127]
    ds_write_b128 v238, a[16:19] offset:16384
    buffer_load_dwordx4 v[164:167], v223, s[28:31], s60 offen offset:1024 sc1
    v_accvgpr_mov_b32 a44, a76
    v_accvgpr_mov_b32 a45, a77
    v_accvgpr_mov_b32 a46, a78
    v_accvgpr_mov_b32 a47, a79
    s_waitcnt vmcnt(14) lgkmcnt(5)
    v_mfma_f32_32x32x16_bf16 a[96:111], a[144:147], v[168:171], a[96:111]
    ds_read_b64_tr_b16 a[128:129], v192 offset:24576
    ds_read_b64_tr_b16 a[130:131], v192 offset:25600
    ds_read_b64_tr_b16 a[132:133], v193 offset:24576
    v_mfma_f32_32x32x16_bf16 a[112:127], a[148:151], v[168:171], a[112:127]
    ds_read_b64_tr_b16 a[134:135], v193 offset:25600
    ds_read_b64_tr_b16 a[136:137], v192 offset:26624
    ds_read_b64_tr_b16 a[138:139], v192 offset:27648
    s_waitcnt lgkmcnt(6)
    v_mfma_f32_32x32x16_bf16 a[96:111], a[152:155], v[172:175], a[96:111]
    ds_read_b64_tr_b16 a[140:141], v193 offset:26624
    ds_read_b64_tr_b16 a[142:143], v193 offset:27648
    buffer_load_dwordx4 v[168:171], v223, s[28:31], s60 offen offset:2048 sc1
    v_accvgpr_mov_b32 a16, a48
    v_accvgpr_mov_b32 a17, a49
    v_accvgpr_mov_b32 a18, a50
    v_accvgpr_mov_b32 a19, a51
    v_mfma_f32_32x32x16_bf16 a[112:127], a[156:159], v[172:175], a[112:127]
    ds_write_b128 v238, a[20:23] offset:17408
    buffer_load_dwordx4 v[172:175], v223, s[28:31], s60 offen offset:3072 sc1
    v_accvgpr_mov_b32 a48, a80
    v_accvgpr_mov_b32 a49, a81
    v_accvgpr_mov_b32 a50, a82
    v_accvgpr_mov_b32 a51, a83
    s_waitcnt vmcnt(14) lgkmcnt(5)
    v_mfma_f32_32x32x16_bf16 a[96:111], a[128:131], v[176:179], a[96:111]
    ds_read_b64_tr_b16 a[144:145], v192 offset:28672
    ds_read_b64_tr_b16 a[146:147], v192 offset:29696
    ds_read_b64_tr_b16 a[148:149], v193 offset:28672
    v_mfma_f32_32x32x16_bf16 a[112:127], a[132:135], v[176:179], a[112:127]
    ds_read_b64_tr_b16 a[150:151], v193 offset:29696
    ds_read_b64_tr_b16 a[152:153], v192 offset:30720
    ds_read_b64_tr_b16 a[154:155], v192 offset:31744
    s_waitcnt lgkmcnt(6)
    v_mfma_f32_32x32x16_bf16 a[96:111], a[136:139], v[180:183], a[96:111]
    ds_read_b64_tr_b16 a[156:157], v193 offset:30720
    ds_read_b64_tr_b16 a[158:159], v193 offset:31744
    buffer_load_dwordx4 v[176:179], v224, s[28:31], s60 offen offset:0 sc1
    v_accvgpr_mov_b32 a20, a52
    v_accvgpr_mov_b32 a21, a53
    v_accvgpr_mov_b32 a22, a54
    v_accvgpr_mov_b32 a23, a55
    v_mfma_f32_32x32x16_bf16 a[112:127], a[140:143], v[180:183], a[112:127]
    ds_write_b128 v238, a[24:27] offset:18432
    buffer_load_dwordx4 v[180:183], v224, s[28:31], s60 offen offset:1024 sc1
    v_accvgpr_mov_b32 a52, a84
    v_accvgpr_mov_b32 a53, a85
    v_accvgpr_mov_b32 a54, a86
    v_accvgpr_mov_b32 a55, a87
    s_waitcnt vmcnt(14) lgkmcnt(5)
    v_mfma_f32_32x32x16_bf16 a[96:111], a[144:147], v[184:187], a[96:111]
    ds_write_b128 v238, a[28:31] offset:19456
    s_add_u32 s46, s45, s44
    s_add_u32 s45, s45, 0x8000
    s_cmp_eq_u32 s45, s76
    s_cselect_b32 s45, 0, s45
    v_mfma_f32_32x32x16_bf16 a[112:127], a[148:151], v[184:187], a[112:127]
    s_waitcnt lgkmcnt(0)
    v_mfma_f32_32x32x16_bf16 a[96:111], a[152:155], v[188:191], a[96:111]
    buffer_load_dwordx4 v[184:187], v224, s[28:31], s60 offen offset:2048 sc1
    v_accvgpr_mov_b32 a24, a56
    v_accvgpr_mov_b32 a25, a57
    v_accvgpr_mov_b32 a26, a58
    v_accvgpr_mov_b32 a27, a59
    v_accvgpr_mov_b32 a56, a88
    v_accvgpr_mov_b32 a57, a89
    v_accvgpr_mov_b32 a58, a90
    v_accvgpr_mov_b32 a59, a91
    v_mfma_f32_32x32x16_bf16 a[112:127], a[156:159], v[188:191], a[112:127]
    buffer_load_dwordx4 v[188:191], v224, s[28:31], s60 offen offset:3072 sc1
    v_accvgpr_mov_b32 a28, a60
    v_accvgpr_mov_b32 a29, a61
    v_accvgpr_mov_b32 a30, a62
    v_accvgpr_mov_b32 a31, a63
    v_accvgpr_mov_b32 a60, a92
    v_accvgpr_mov_b32 a61, a93
    v_accvgpr_mov_b32 a62, a94
    v_accvgpr_mov_b32 a63, a95
    s_add_u32 s61, s61, 0x20000
    s_xor_b32 s59, s61, s62
    s_add_u32 s60, s59, 0x10000
    s_mov_b32 m0, s46
    s_sub_u32 s47, s47, 1
    s_cbranch_scc0 Llp_25
    s_mov_b32 s47, 3
    s_call_b64 s[40:41], LPN9
    s_nop 7
    s_nop 3
    v_accvgpr_read_b32 v0, a96
    v_accvgpr_read_b32 v1, a97
    v_accvgpr_read_b32 v2, a98
    v_accvgpr_read_b32 v3, a99
    v_accvgpr_read_b32 v4, a100
    v_accvgpr_read_b32 v5, a101
    v_accvgpr_read_b32 v6, a102
    v_accvgpr_read_b32 v7, a103
    v_accvgpr_read_b32 v8, a104
    v_accvgpr_read_b32 v9, a105
    v_accvgpr_read_b32 v10, a106
    v_accvgpr_read_b32 v11, a107
    v_accvgpr_read_b32 v12, a108
    v_accvgpr_read_b32 v13, a109
    v_accvgpr_read_b32 v14, a110
    v_accvgpr_read_b32 v15, a111
    v_accvgpr_read_b32 v16, a112
    v_accvgpr_read_b32 v17, a113
    v_accvgpr_read_b32 v18, a114
    v_accvgpr_read_b32 v19, a115
    v_accvgpr_read_b32 v20, a116
    v_accvgpr_read_b32 v21, a117
    v_accvgpr_read_b32 v22, a118
    v_accvgpr_read_b32 v23, a119
    v_accvgpr_read_b32 v24, a120
    v_accvgpr_read_b32 v25, a121
    v_accvgpr_read_b32 v26, a122
    v_accvgpr_read_b32 v27, a123
    v_accvgpr_read_b32 v28, a124
    v_accvgpr_read_b32 v29, a125
    v_accvgpr_read_b32 v30, a126
    v_accvgpr_read_b32 v31, a127
    v_cvt_pk_bf16_f32 v64, v0, v1
    v_cvt_pk_bf16_f32 v65, v2, v3
    v_cvt_pk_bf16_f32 v66, v4, v5
    v_cvt_pk_bf16_f32 v67, v6, v7
    v_cvt_pk_bf16_f32 v68, v8, v9
    v_cvt_pk_bf16_f32 v69, v10, v11
    v_cvt_pk_bf16_f32 v70, v12, v13
    v_cvt_pk_bf16_f32 v71, v14, v15
    v_cvt_pk_bf16_f32 v72, v16, v17
    v_cvt_pk_bf16_f32 v73, v18, v19
    v_cvt_pk_bf16_f32 v74, v20, v21
    v_cvt_pk_bf16_f32 v75, v22, v23
    v_cvt_pk_bf16_f32 v76, v24, v25
    v_cvt_pk_bf16_f32 v77, v26, v27
    v_cvt_pk_bf16_f32 v78, v28, v29
    v_cvt_pk_bf16_f32 v79, v30, v31
    buffer_store_dwordx4 v[64:67], v225, s[32:35], 0 offen offset:0
    buffer_store_dwordx4 v[68:71], v225, s[32:35], 0 offen offset:32
    buffer_store_dwordx4 v[72:75], v225, s[32:35], 0 offen offset:64
    buffer_store_dwordx4 v[76:79], v225, s[32:35], 0 offen offset:96
Lend:
    s_endpgm
LQQ0:
    v_add_u32 v192, s45, v206
    v_add_u32 v196, s45, v207
    v_xor_b32 v197, 64, v196
    s_waitcnt vmcnt(24) lgkmcnt(0)
    v_mfma_f32_32x32x16_bf16 v[128:143], a[152:155], a[148:151], v[128:143]
    s_barrier
    ds_read_b128 a[128:131], v192
    ds_read_b64_tr_b16 a[132:133], v196 offset:16384
    ds_read_b64_tr_b16 a[134:135], v196 offset:17408
    v_xor_b32 v198, 128, v196
    v_xor_b32 v199, 192, v196
    v_mfma_f32_32x32x16_bf16 v[144:159], a[156:159], a[148:151], v[144:159]
    ds_read_b64_tr_b16 a[136:137], v197 offset:16384
    ds_read_b64_tr_b16 a[138:139], v197 offset:17408
    ds_read_b64_tr_b16 a[140:141], v198 offset:16384
    v_xor_b32 v193, 32, v192
    v_xor_b32 v194, 64, v192
    v_xor_b32 v195, 96, v192
    v_mfma_f32_32x32x16_bf16 v[160:175], a[160:163], a[148:151], v[160:175]
    ds_read_b64_tr_b16 a[142:143], v198 offset:17408
    ds_read_b64_tr_b16 a[144:145], v199 offset:16384
    ds_read_b64_tr_b16 a[146:147], v199 offset:17408
    v_mfma_f32_32x32x16_bf16 v[176:191], a[164:167], a[148:151], v[176:191]
    buffer_load_dwordx4 v211, s[4:7], s51 offen offset:0 lds
    s_add_u32 s46, s45, s44
    s_add_u32 s45, s45, 0x8000
    buffer_load_dwordx4 v212, s[4:7], s51 offen offset:1024 lds
    s_waitcnt lgkmcnt(3)
    v_mfma_f32_32x32x16_bf16 v[128:143], a[132:135], a[128:131], v[128:143]
    ds_read_b128 a[148:151], v193
    ds_read_b64_tr_b16 a[152:153], v196 offset:20480
    ds_read_b64_tr_b16 a[154:155], v196 offset:21504
    v_mfma_f32_32x32x16_bf16 v[144:159], a[136:139], a[128:131], v[144:159]
    ds_read_b64_tr_b16 a[156:157], v197 offset:20480
    ds_read_b64_tr_b16 a[158:159], v197 offset:21504
    ds_read_b64_tr_b16 a[160:161], v198 offset:20480
    s_waitcnt lgkmcnt(6)
    v_mfma_f32_32x32x16_bf16 v[160:175], a[140:143], a[128:131], v[160:175]
    ds_read_b64_tr_b16 a[162:163], v198 offset:21504
    ds_read_b64_tr_b16 a[164:165], v199 offset:20480
    ds_read_b64_tr_b16 a[166:167], v199 offset:21504
    v_mfma_f32_32x32x16_bf16 v[176:191], a[144:147], a[128:131], v[176:191]
    buffer_load_dwordx4 v213, s[4:7], s51 offen offset:2048 lds
    s_cmp_eq_u32 s45, s76
    s_cselect_b32 s45, 0, s45
    buffer_load_dwordx4 v214, s[4:7], s51 offen offset:3072 lds
    s_add_u32 m0, m0, 0x4000
    s_waitcnt lgkmcnt(3)
    v_mfma_f32_32x32x16_bf16 v[128:143], a[152:155], a[148:151], v[128:143]
    ds_read_b128 a[128:131], v194
    ds_read_b64_tr_b16 a[132:133], v196 offset:24576
    ds_read_b64_tr_b16 a[134:135], v196 offset:25600
    v_mfma_f32_32x32x16_bf16 v[144:159], a[156:159], a[148:151], v[144:159]
    ds_read_b64_tr_b16 a[136:137], v197 offset:24576
    ds_read_b64_tr_b16 a[138:139], v197 offset:25600
    ds_read_b64_tr_b16 a[140:141], v198 offset:24576
    s_waitcnt lgkmcnt(6)
    v_mfma_f32_32x32x16_bf16 v[160:175], a[160:163], a[148:151], v[160:175]
    ds_read_b64_tr_b16 a[142:143], v198 offset:25600
    ds_read_b64_tr_b16 a[144:145], v199 offset:24576
    ds_read_b64_tr_b16 a[146:147], v199 offset:25600
    v_mfma_f32_32x32x16_bf16 v[176:191], a[164:167], a[148:151], v[176:191]
    buffer_load_dwordx4 v215, s[8:11], s52 offen offset:0 lds
    buffer_load_dwordx4 v216, s[8:11], s52 offen offset:1024 lds
    s_waitcnt lgkmcnt(3)
    v_mfma_f32_32x32x16_bf16 v[128:143], a[132:135], a[128:131], v[128:143]
    ds_read_b128 a[148:151], v195
    ds_read_b64_tr_b16 a[152:153], v196 offset:28672
    ds_read_b64_tr_b16 a[154:155], v196 offset:29696
    v_mfma_f32_32x32x16_bf16 v[144:159], a[136:139], a[128:131], v[144:159]
    ds_read_b64_tr_b16 a[156:157], v197 offset:28672
    ds_read_b64_tr_b16 a[158:159], v197 offset:29696
    ds_read_b64_tr_b16 a[160:161], v198 offset:28672
    s_waitcnt lgkmcnt(6)
    v_mfma_f32_32x32x16_bf16 v[160:175], a[140:143], a[128:131], v[160:175]
    ds_read_b64_tr_b16 a[162:163], v198 offset:29696
    ds_read_b64_tr_b16 a[164:165], v199 offset:28672
    ds_read_b64_tr_b16 a[166:167], v199 offset:29696
    v_mfma_f32_32x32x16_bf16 v[176:191], a[144:147], a[128:131], v[176:191]
    buffer_load_dwordx4 v217, s[8:11], s52 offen offset:2048 lds
    buffer_load_dwordx4 v218, s[8:11], s52 offen offset:3072 lds
    s_add_u32 s62, s62, 0x80
    s_xor_b32 s51, s62, s66
    s_lshl_b32 s52, s51, 12
    s_add_u32 s52, s52, s53
    s_mov_b32 m0, s46
    s_sub_u32 s47, s47, 1
    s_cbranch_scc0 LQQ0
    s_setpc_b64 s[40:41]
LQA1:
    v_add_u32 v192, s45, v206
    v_add_u32 v196, s45, v207
    v_xor_b32 v197, 64, v196
    s_waitcnt vmcnt(24) lgkmcnt(0)
    v_mfma_f32_32x32x16_bf16 v[128:143], a[152:155], a[148:151], v[128:143]
    s_barrier
    ds_read_b128 a[128:131], v192
    ds_read_b64_tr_b16 a[132:133], v196 offset:16384
    ds_read_b64_tr_b16 a[134:135], v196 offset:17408
    v_xor_b32 v198, 128, v196
    v_xor_b32 v199, 192, v196
    v_mfma_f32_32x32x16_bf16 v[144:159], a[156:159], a[148:151], v[144:159]
    ds_read_b64_tr_b16 a[136:137], v197 offset:16384
    ds_read_b64_tr_b16 a[138:139], v197 offset:17408
    ds_read_b64_tr_b16 a[140:141], v198 offset:16384
    v_xor_b32 v193, 32, v192
    v_xor_b32 v194, 64, v192
    v_xor_b32 v195, 96, v192
    v_mfma_f32_32x32x16_bf16 v[160:175], a[160:163], a[148:151], v[160:175]
    ds_read_b64_tr_b16 a[142:143], v198 offset:17408
    ds_read_b64_tr_b16 a[144:145], v199 offset:16384
    ds_read_b64_tr_b16 a[146:147], v199 offset:17408
    v_mfma_f32_32x32x16_bf16 v[176:191], a[164:167], a[148:151], v[176:191]
    buffer_load_dwordx4 v209, s[12:15], s48 offen offset:0 nt lds
    s_add_u32 s46, s45, s44
    s_add_u32 s45, s45, 0x8000
    buffer_load_dwordx4 v209, s[12:15], s48 offen offset:1024 nt lds
    s_waitcnt lgkmcnt(3)
    v_mfma_f32_32x32x16_bf16 v[128:143], a[132:135], a[128:131], v[128:143]
    ds_read_b128 a[148:151], v193
    ds_read_b64_tr_b16 a[152:153], v196 offset:20480
    ds_read_b64_tr_b16 a[154:155], v196 offset:21504
    v_mfma_f32_32x32x16_bf16 v[144:159], a[136:139], a[128:131], v[144:159]
    ds_read_b64_tr_b16 a[156:157], v197 offset:20480
    ds_read_b64_tr_b16 a[158:159], v197 offset:21504
    ds_read_b64_tr_b16 a[160:161], v198 offset:20480
    s_waitcnt lgkmcnt(6)
    v_mfma_f32_32x32x16_bf16 v[160:175], a[140:143], a[128:131], v[160:175]
    ds_read_b64_tr_b16 a[162:163], v198 offset:21504
    ds_read_b64_tr_b16 a[164:165], v199 offset:20480
    ds_read_b64_tr_b16 a[166:167], v199 offset:21504
    v_mfma_f32_32x32x16_bf16 v[176:191], a[144:147], a[128:131], v[176:191]
    buffer_load_dwordx4 v209, s[12:15], s48 offen offset:2048 nt lds
    s_cmp_eq_u32 s45, s76
    s_cselect_b32 s45, 0, s45
    buffer_load_dwordx4 v209, s[12:15], s48 offen offset:3072 nt lds
    s_add_u32 m0, m0, 0x4000
    s_waitcnt lgkmcnt(3)
    v_mfma_f32_32x32x16_bf16 v[128:143], a[152:155], a[148:151], v[128:143]
    ds_read_b128 a[128:131], v194
    ds_read_b64_tr_b16 a[132:133], v196 offset:24576
    ds_read_b64_tr_b16 a[134:135], v196 offset:25600
    v_mfma_f32_32x32x16_bf16 v[144:159], a[156:159], a[148:151], v[144:159]
    ds_read_b64_tr_b16 a[136:137], v197 offset:24576
    ds_read_b64_tr_b16 a[138:139], v197 offset:25600
    ds_read_b64_tr_b16 a[140:141], v198 offset:24576
    s_waitcnt lgkmcnt(6)
    v_mfma_f32_32x32x16_bf16 v[160:175], a[160:163], a[148:151], v[160:175]
    ds_read_b64_tr_b16 a[142:143], v198 offset:25600
    ds_read_b64_tr_b16 a[144:145], v199 offset:24576
    ds_read_b64_tr_b16 a[146:147], v199 offset:25600
    v_mfma_f32_32x32x16_bf16 v[176:191], a[164:167], a[148:151], v[176:191]
    buffer_load_dwordx4 v210, s[16:19], s48 offen offset:0 nt lds
    buffer_load_dwordx4 v210, s[16:19], s48 offen offset:1024 nt lds
    s_waitcnt lgkmcnt(3)
    v_mfma_f32_32x32x16_bf16 v[128:143], a[132:135], a[128:131], v[128:143]
    ds_read_b128 a[148:151], v195
    ds_read_b64_tr_b16 a[152:153], v196 offset:28672
    ds_read_b64_tr_b16 a[154:155], v196 offset:29696
    v_mfma_f32_32x32x16_bf16 v[144:159], a[136:139], a[128:131], v[144:159]
    ds_read_b64_tr_b16 a[156:157], v197 offset:28672
    ds_read_b64_tr_b16 a[158:159], v197 offset:29696
    ds_read_b64_tr_b16 a[160:161], v198 offset:28672
    s_waitcnt lgkmcnt(6)
    v_mfma_f32_32x32x16_bf16 v[160:175], a[140:143], a[128:131], v[160:175]
    ds_read_b64_tr_b16 a[162:163], v198 offset:29696
    ds_read_b64_tr_b16 a[164:165], v199 offset:28672
    ds_read_b64_tr_b16 a[166:167], v199 offset:29696
    v_mfma_f32_32x32x16_bf16 v[176:191], a[144:147], a[128:131], v[176:191]
    buffer_load_dwordx4 v210, s[16:19], s49 offen offset:2048 nt lds
    buffer_load_dwordx4 v210, s[16:19], s49 offen offset:3072 nt lds
    s_mov_b32 s49, s48
    s_add_u32 s48, s48, 0x4000
    s_mov_b32 m0, s46
    s_sub_u32 s47, s47, 1
    s_cbranch_scc0 LQA1
    s_setpc_b64 s[40:41]
LQF:
    s_waitcnt lgkmcnt(0)
    v_mfma_f32_32x32x16_bf16 v[128:143], a[152:155], a[148:151], v[128:143]
    v_mfma_f32_32x32x16_bf16 v[144:159], a[156:159], a[148:151], v[144:159]
    v_mfma_f32_32x32x16_bf16 v[160:175], a[160:163], a[148:151], v[160:175]
    v_mfma_f32_32x32x16_bf16 v[176:191], a[164:167], a[148:151], v[176:191]
    s_nop 8
    v_pk_mul_f32 v[128:129], v[128:129], s[74:75]
    v_pk_mul_f32 v[130:131], v[130:131], s[74:75]
    v_pk_mul_f32 v[132:133], v[132:133], s[74:75]
    v_pk_mul_f32 v[134:135], v[134:135], s[74:75]
    v_pk_mul_f32 v[136:137], v[136:137], s[74:75]
    v_pk_mul_f32 v[138:139], v[138:139], s[74:75]
    v_pk_mul_f32 v[140:141], v[140:141], s[74:75]
    v_pk_mul_f32 v[142:143], v[142:143], s[74:75]
    v_cvt_pk_bf16_f32 v128, v128, v129
    v_cvt_pk_bf16_f32 v129, v130, v131
    v_cvt_pk_bf16_f32 v130, v132, v133
    v_cvt_pk_bf16_f32 v131, v134, v135
    v_cvt_pk_bf16_f32 v132, v136, v137
    v_cvt_pk_bf16_f32 v133, v138, v139
    v_cvt_pk_bf16_f32 v134, v140, v141
    v_cvt_pk_bf16_f32 v135, v142, v143
    v_accvgpr_write_b32 a0, v128
    v_accvgpr_write_b32 a1, v129
    v_accvgpr_write_b32 a2, v130
    v_accvgpr_write_b32 a3, v131
    v_accvgpr_write_b32 a4, v132
    v_accvgpr_write_b32 a5, v133
    v_accvgpr_write_b32 a6, v134
    v_accvgpr_write_b32 a7, v135
    v_pk_mul_f32 v[144:145], v[144:145], s[74:75]
    v_pk_mul_f32 v[146:147], v[146:147], s[74:75]
    v_pk_mul_f32 v[148:149], v[148:149], s[74:75]
    v_pk_mul_f32 v[150:151], v[150:151], s[74:75]
    v_pk_mul_f32 v[152:153], v[152:153], s[74:75]
    v_pk_mul_f32 v[154:155], v[154:155], s[74:75]
    v_pk_mul_f32 v[156:157], v[156:157], s[74:75]
    v_pk_mul_f32 v[158:159], v[158:159], s[74:75]
    v_cvt_pk_bf16_f32 v144, v144, v145
    v_cvt_pk_bf16_f32 v145, v146, v147
    v_cvt_pk_bf16_f32 v146, v148, v149
    v_cvt_pk_bf16_f32 v147, v150, v151
    v_cvt_pk_bf16_f32 v148, v152, v153
    v_cvt_pk_bf16_f32 v149, v154, v155
    v_cvt_pk_bf16_f32 v150, v156, v157
    v_cvt_pk_bf16_f32 v151, v158, v159
    v_accvgpr_write_b32 a8, v144
    v_accvgpr_write_b32 a9, v145
    v_accvgpr_write_b32 a10, v146
    v_accvgpr_write_b32 a11, v147
    v_accvgpr_write_b32 a12, v148
    v_accvgpr_write_b32 a13, v149
    v_accvgpr_write_b32 a14, v150
    v_accvgpr_write_b32 a15, v151
    v_pk_mul_f32 v[160:161], v[160:161], s[74:75]
    v_pk_mul_f32 v[162:163], v[162:163], s[74:75]
    v_pk_mul_f32 v[164:165], v[164:165], s[74:75]
    v_pk_mul_f32 v[166:167], v[166:167], s[74:75]
    v_pk_mul_f32 v[168:169], v[168:169], s[74:75]
    v_pk_mul_f32 v[170:171], v[170:171], s[74:75]
    v_pk_mul_f32 v[172:173], v[172:173], s[74:75]
    v_pk_mul_f32 v[174:175], v[174:175], s[74:75]
    v_cvt_pk_bf16_f32 v160, v160, v161
    v_cvt_pk_bf16_f32 v161, v162, v163
    v_cvt_pk_bf16_f32 v162, v164, v165
    v_cvt_pk_bf16_f32 v163, v166, v167
    v_cvt_pk_bf16_f32 v164, v168, v169
    v_cvt_pk_bf16_f32 v165, v170, v171
    v_cvt_pk_bf16_f32 v166, v172, v173
    v_cvt_pk_bf16_f32 v167, v174, v175
    v_accvgpr_write_b32 a16, v160
    v_accvgpr_write_b32 a17, v161
    v_accvgpr_write_b32 a18, v162
    v_accvgpr_write_b32 a19, v163
    v_accvgpr_write_b32 a20, v164
    v_accvgpr_write_b32 a21, v165
    v_accvgpr_write_b32 a22, v166
    v_accvgpr_write_b32 a23, v167
    v_pk_mul_f32 v[176:177], v[176:177], s[74:75]
    v_pk_mul_f32 v[178:179], v[178:179], s[74:75]
    v_pk_mul_f32 v[180:181], v[180:181], s[74:75]
    v_pk_mul_f32 v[182:183], v[182:183], s[74:75]
    v_pk_mul_f32 v[184:185], v[184:185], s[74:75]
    v_pk_mul_f32 v[186:187], v[186:187], s[74:75]
    v_pk_mul_f32 v[188:189], v[188:189], s[74:75]
    v_pk_mul_f32 v[190:191], v[190:191], s[74:75]
    v_cvt_pk_bf16_f32 v176, v176, v177
    v_cvt_pk_bf16_f32 v177, v178, v179
    v_cvt_pk_bf16_f32 v178, v180, v181
    v_cvt_pk_bf16_f32 v179, v182, v183
    v_cvt_pk_bf16_f32 v180, v184, v185
    v_cvt_pk_bf16_f32 v181, v186, v187
    v_cvt_pk_bf16_f32 v182, v188, v189
    v_cvt_pk_bf16_f32 v183, v190, v191
    v_accvgpr_write_b32 a24, v176
    v_accvgpr_write_b32 a25, v177
    v_accvgpr_write_b32 a26, v178
    v_accvgpr_write_b32 a27, v179
    v_accvgpr_write_b32 a28, v180
    v_accvgpr_write_b32 a29, v181
    v_accvgpr_write_b32 a30, v182
    v_accvgpr_write_b32 a31, v183
    s_mov_b32 s63, 1
    s_mov_b32 s65, 0
    s_setpc_b64 s[40:41]
LAA2:
    s_waitcnt vmcnt(24) lgkmcnt(0)
    v_mfma_f32_32x32x16_bf16 v[0:15], a[64:67], v[96:99], v[0:15]
    s_barrier
    v_add_u32 v192, s45, v204
    v_xor_b32 v193, 32, v192
    v_xor_b32 v194, 64, v192
    v_xor_b32 v195, 96, v192
    v_mfma_f32_32x32x16_bf16 v[16:31], a[68:71], v[96:99], v[16:31]
    ds_read_b128 a[32:35], v192 offset:0
    ds_read_b128 a[36:39], v193 offset:0
    v_xor_b32 v196, 128, v192
    v_xor_b32 v197, 160, v192
    v_exp_f32 v232, v80
    v_mfma_f32_32x32x16_bf16 v[32:47], a[72:75], v[96:99], v[32:47]
    ds_read_b128 a[40:43], v194 offset:0
    ds_read_b128 a[44:47], v195 offset:0
    v_xor_b32 v198, 192, v192
    v_xor_b32 v199, 224, v192
    v_exp_f32 v233, v81
    v_mfma_f32_32x32x16_bf16 v[48:63], a[76:79], v[96:99], v[48:63]
    ds_read_b128 a[48:51], v196 offset:0
    ds_read_b128 a[52:55], v197 offset:0
    v_exp_f32 v234, v82
    v_cvt_pk_bf16_f32 v104, v232, v233
    v_mfma_f32_32x32x16_bf16 v[0:15], a[80:83], v[100:103], v[0:15]
    ds_read_b128 a[56:59], v198 offset:0
    ds_read_b128 a[60:63], v199 offset:0
    v_exp_f32 v235, v83
    v_exp_f32 v232, v84
    v_mfma_f32_16x16x32_bf16 v[228:231], a[168:171], v[96:99], v[228:231]
    v_add_u32 v200, s45, v205
    v_xor_b32 v201, 64, v200
    v_mfma_f32_32x32x16_bf16 v[16:31], a[84:87], v[100:103], v[16:31]
    buffer_load_dwordx4 v209, s[12:15], s48 offen offset:0 nt lds
    v_cvt_pk_bf16_f32 v105, v234, v235
    v_exp_f32 v233, v85
    v_mfma_f32_32x32x16_bf16 v[32:47], a[88:91], v[100:103], v[32:47]
    v_exp_f32 v234, v86
    v_cvt_pk_bf16_f32 v106, v232, v233
    v_exp_f32 v235, v87
    v_or3_b32 v226, v104, v105, v106
    v_mfma_f32_16x16x32_bf16 v[228:231], a[168:171], v[100:103], v[228:231]
    v_xor_b32 v202, 128, v200
    v_xor_b32 v203, 192, v200
    v_mfma_f32_32x32x16_bf16 v[48:63], a[92:95], v[100:103], v[48:63]
    buffer_load_dwordx4 v209, s[12:15], s48 offen offset:1024 nt lds
    v_exp_f32 v232, v88
    v_cvt_pk_bf16_f32 v107, v234, v235
    s_waitcnt lgkmcnt(0)
    v_mfma_f32_32x32x16_bf16 v[64:79], a[32:35], a[0:3], v[112:127]
    ds_read_b64_tr_b16 a[64:65], v200 offset:18432
    ds_read_b64_tr_b16 a[66:67], v200 offset:22528
    ds_read_b64_tr_b16 a[68:69], v201 offset:18432
    v_exp_f32 v233, v89
    v_mfma_f32_32x32x16_bf16 v[64:79], a[36:39], a[4:7], v[64:79]
    ds_read_b64_tr_b16 a[70:71], v201 offset:22528
    ds_read_b64_tr_b16 a[72:73], v202 offset:18432
    ds_read_b64_tr_b16 a[74:75], v202 offset:22528
    v_exp_f32 v234, v90
    v_cvt_pk_bf16_f32 v108, v232, v233
    v_mfma_f32_32x32x16_bf16 v[64:79], a[40:43], a[8:11], v[64:79]
    ds_read_b64_tr_b16 a[76:77], v203 offset:18432
    ds_read_b64_tr_b16 a[78:79], v203 offset:22528
    ds_read_b64_tr_b16 a[80:81], v200 offset:26624
    v_exp_f32 v235, v91
    v_or3_b32 v226, v226, v107, v108
    v_mfma_f32_32x32x16_bf16 v[64:79], a[44:47], a[12:15], v[64:79]
    ds_read_b64_tr_b16 a[82:83], v200 offset:30720
    ds_read_b64_tr_b16 a[84:85], v201 offset:26624
    ds_read_b64_tr_b16 a[86:87], v201 offset:30720
    v_exp_f32 v232, v92
    v_cvt_pk_bf16_f32 v109, v234, v235
    v_mfma_f32_32x32x16_bf16 v[64:79], a[48:51], a[16:19], v[64:79]
    ds_read_b64_tr_b16 a[88:89], v202 offset:26624
    ds_read_b64_tr_b16 a[90:91], v202 offset:30720
    v_exp_f32 v233, v93
    v_mfma_f32_32x32x16_bf16 v[64:79], a[52:55], a[20:23], v[64:79]
    ds_read_b64_tr_b16 a[92:93], v203 offset:26624
    ds_read_b64_tr_b16 a[94:95], v203 offset:30720
    buffer_load_dwordx4 v209, s[12:15], s48 offen offset:2048 nt lds
    v_exp_f32 v234, v94
    v_cvt_pk_bf16_f32 v110, v232, v233
    v_mfma_f32_32x32x16_bf16 v[64:79], a[56:59], a[24:27], v[64:79]
    v_exp_f32 v235, v95
    v_or3_b32 v226, v226, v109, v110
    v_cvt_pk_bf16_f32 v111, v234, v235
    v_bitop3_b32 v226, v226, s65, v111 bitop3:0xc8
    v_cmp_ne_u32 vcc, 0, v226
    v_mfma_f32_32x32x16_bf16 v[64:79], a[60:63], a[28:31], v[64:79]
    buffer_load_dwordx4 v209, s[12:15], s48 offen offset:3072 nt lds
    s_cbranch_vccnz Ltr_26
Lbk_27:
    s_waitcnt lgkmcnt(0)
    v_mfma_f32_32x32x16_bf16 v[0:15], a[64:67], v[104:107], v[0:15]
    ds_read_b128 a[32:35], v192 offset:2048
    ds_read_b128 a[36:39], v193 offset:2048
    s_add_u32 m0, m0, 0x4000
    v_mfma_f32_32x32x16_bf16 v[16:31], a[68:71], v[104:107], v[16:31]
    ds_read_b128 a[40:43], v194 offset:2048
    ds_read_b128 a[44:47], v195 offset:2048
    v_exp_f32 v232, v64
    v_mfma_f32_32x32x16_bf16 v[32:47], a[72:75], v[104:107], v[32:47]
    ds_read_b128 a[48:51], v196 offset:2048
    ds_read_b128 a[52:55], v197 offset:2048
    v_exp_f32 v233, v65
    v_exp_f32 v234, v66
    v_mfma_f32_32x32x16_bf16 v[48:63], a[76:79], v[104:107], v[48:63]
    ds_read_b128 a[56:59], v198 offset:2048
    ds_read_b128 a[60:63], v199 offset:2048
    v_cvt_pk_bf16_f32 v96, v232, v233
    v_exp_f32 v235, v67
    v_mfma_f32_32x32x16_bf16 v[0:15], a[80:83], v[108:111], v[0:15]
    v_exp_f32 v232, v68
    v_cvt_pk_bf16_f32 v97, v234, v235
    v_exp_f32 v233, v69
    v_mfma_f32_16x16x32_bf16 v[228:231], a[168:171], v[104:107], v[228:231]
    s_add_u32 s46, s45, s44
    s_add_u32 s45, s45, 0x8000
    v_mfma_f32_32x32x16_bf16 v[16:31], a[84:87], v[108:111], v[16:31]
    buffer_load_dwordx4 v210, s[16:19], s48 offen offset:0 nt lds
    v_exp_f32 v234, v70
    v_cvt_pk_bf16_f32 v98, v232, v233
    v_mfma_f32_32x32x16_bf16 v[32:47], a[88:91], v[108:111], v[32:47]
    v_exp_f32 v235, v71
    v_or3_b32 v226, v96, v97, v98
    v_exp_f32 v232, v72
    v_cvt_pk_bf16_f32 v99, v234, v235
    v_mfma_f32_16x16x32_bf16 v[228:231], a[168:171], v[108:111], v[228:231]
    s_cmp_eq_u32 s45, s76
    s_cselect_b32 s45, 0, s45
    v_mfma_f32_32x32x16_bf16 v[48:63], a[92:95], v[108:111], v[48:63]
    buffer_load_dwordx4 v210, s[16:19], s48 offen offset:1024 nt lds
    v_exp_f32 v233, v73
    s_waitcnt lgkmcnt(0)
    v_mfma_f32_32x32x16_bf16 v[80:95], a[32:35], a[0:3], v[112:127]
    ds_read_b64_tr_b16 a[64:65], v200 offset:16384
    ds_read_b64_tr_b16 a[66:67], v200 offset:20480
    ds_read_b64_tr_b16 a[68:69], v201 offset:16384
    v_exp_f32 v234, v74
    v_cvt_pk_bf16_f32 v100, v232, v233
    v_mfma_f32_32x32x16_bf16 v[80:95], a[36:39], a[4:7], v[80:95]
    ds_read_b64_tr_b16 a[70:71], v201 offset:20480
    ds_read_b64_tr_b16 a[72:73], v202 offset:16384
    ds_read_b64_tr_b16 a[74:75], v202 offset:20480
    v_exp_f32 v235, v75
    v_or3_b32 v226, v226, v99, v100
    v_mfma_f32_32x32x16_bf16 v[80:95], a[40:43], a[8:11], v[80:95]
    ds_read_b64_tr_b16 a[76:77], v203 offset:16384
    ds_read_b64_tr_b16 a[78:79], v203 offset:20480
    ds_read_b64_tr_b16 a[80:81], v200 offset:24576
    v_exp_f32 v232, v76
    v_mfma_f32_32x32x16_bf16 v[80:95], a[44:47], a[12:15], v[80:95]
    ds_read_b64_tr_b16 a[82:83], v200 offset:28672
    ds_read_b64_tr_b16 a[84:85], v201 offset:24576
    ds_read_b64_tr_b16 a[86:87], v201 offset:28672
    v_cvt_pk_bf16_f32 v101, v234, v235
    v_mfma_f32_32x32x16_bf16 v[80:95], a[48:51], a[16:19], v[80:95]
    ds_read_b64_tr_b16 a[88:89], v202 offset:24576
    ds_read_b64_tr_b16 a[90:91], v202 offset:28672
    v_exp_f32 v233, v77
    v_exp_f32 v234, v78
    v_mfma_f32_32x32x16_bf16 v[80:95], a[52:55], a[20:23], v[80:95]
    ds_read_b64_tr_b16 a[92:93], v203 offset:24576
    ds_read_b64_tr_b16 a[94:95], v203 offset:28672
    buffer_load_dwordx4 v210, s[16:19], s49 offen offset:2048 nt lds
    v_cvt_pk_bf16_f32 v102, v232, v233
    v_exp_f32 v235, v79
    v_mfma_f32_32x32x16_bf16 v[80:95], a[56:59], a[24:27], v[80:95]
    v_or3_b32 v226, v226, v101, v102
    v_cvt_pk_bf16_f32 v103, v234, v235
    v_bitop3_b32 v226, v226, s64, v103 bitop3:0xc8
    v_cmp_ne_u32 vcc, s63, v226
    v_mfma_f32_32x32x16_bf16 v[80:95], a[60:63], a[28:31], v[80:95]
    buffer_load_dwordx4 v210, s[16:19], s49 offen offset:3072 nt lds
    s_mov_b32 s49, s48
    s_add_u32 s48, s48, 0x4000
    s_mov_b32 m0, s46
    s_sub_u32 s47, s47, 1
    s_cbranch_vccnz Ltr_28
Lbk_29:
    s_cbranch_scc0 LAA2
    s_setpc_b64 s[40:41]
LE:
    s_waitcnt vmcnt(63) lgkmcnt(0)
    v_mfma_f32_32x32x16_bf16 v[0:15], a[64:67], v[96:99], v[0:15]
    s_barrier
    v_add_u32 v200, s45, v205
    v_xor_b32 v201, 64, v200
    v_xor_b32 v202, 128, v200
    v_xor_b32 v203, 192, v200
    v_mfma_f32_32x32x16_bf16 v[16:31], a[68:71], v[96:99], v[16:31]
    ds_read_b64_tr_b16 a[64:65], v200 offset:18432
    ds_read_b64_tr_b16 a[66:67], v200 offset:22528
    v_exp_f32 v232, v80
    v_exp_f32 v233, v81
    v_exp_f32 v234, v82
    v_cvt_pk_bf16_f32 v104, v232, v233
    v_mfma_f32_16x16x32_bf16 v[228:231], a[168:171], v[96:99], v[228:231]
    v_mfma_f32_32x32x16_bf16 v[32:47], a[72:75], v[96:99], v[32:47]
    ds_read_b64_tr_b16 a[68:69], v201 offset:18432
    ds_read_b64_tr_b16 a[70:71], v201 offset:22528
    v_exp_f32 v235, v83
    v_exp_f32 v232, v84
    v_cvt_pk_bf16_f32 v105, v234, v235
    v_exp_f32 v233, v85
    v_mfma_f32_16x16x32_bf16 v[228:231], a[168:171], v[100:103], v[228:231]
    v_mfma_f32_32x32x16_bf16 v[48:63], a[76:79], v[96:99], v[48:63]
    ds_read_b64_tr_b16 a[72:73], v202 offset:18432
    ds_read_b64_tr_b16 a[74:75], v202 offset:22528
    v_exp_f32 v234, v86
    v_cvt_pk_bf16_f32 v106, v232, v233
    v_exp_f32 v235, v87
    v_or3_b32 v226, v104, v105, v106
    v_mfma_f32_32x32x16_bf16 v[0:15], a[80:83], v[100:103], v[0:15]
    ds_read_b64_tr_b16 a[76:77], v203 offset:18432
    ds_read_b64_tr_b16 a[78:79], v203 offset:22528
    v_exp_f32 v232, v88
    v_cvt_pk_bf16_f32 v107, v234, v235
    v_exp_f32 v233, v89
    v_exp_f32 v234, v90
    v_mfma_f32_32x32x16_bf16 v[16:31], a[84:87], v[100:103], v[16:31]
    ds_read_b64_tr_b16 a[80:81], v200 offset:26624
    ds_read_b64_tr_b16 a[82:83], v200 offset:30720
    v_cvt_pk_bf16_f32 v108, v232, v233
    v_exp_f32 v235, v91
    v_or3_b32 v226, v226, v107, v108
    v_exp_f32 v232, v92
    v_cvt_pk_bf16_f32 v109, v234, v235
    v_mfma_f32_32x32x16_bf16 v[32:47], a[88:91], v[100:103], v[32:47]
    ds_read_b64_tr_b16 a[84:85], v201 offset:26624
    ds_read_b64_tr_b16 a[86:87], v201 offset:30720
    v_exp_f32 v233, v93
    v_exp_f32 v234, v94
    v_cvt_pk_bf16_f32 v110, v232, v233
    v_mfma_f32_32x32x16_bf16 v[48:63], a[92:95], v[100:103], v[48:63]
    ds_read_b64_tr_b16 a[88:89], v202 offset:26624
    ds_read_b64_tr_b16 a[90:91], v202 offset:30720
    ds_read_b64_tr_b16 a[92:93], v203 offset:26624
    ds_read_b64_tr_b16 a[94:95], v203 offset:30720
    v_exp_f32 v235, v95
    v_or3_b32 v226, v226, v109, v110
    v_cvt_pk_bf16_f32 v111, v234, v235
    v_bitop3_b32 v226, v226, s65, v111 bitop3:0xc8
    v_cmp_ne_u32 vcc, 0, v226
    s_cbranch_vccnz Ltr_30
Lbk_31:
    s_waitcnt lgkmcnt(0)
    v_mfma_f32_16x16x32_bf16 v[228:231], a[168:171], v[104:107], v[228:231]
    v_mfma_f32_16x16x32_bf16 v[228:231], a[168:171], v[108:111], v[228:231]
    v_mfma_f32_32x32x16_bf16 v[0:15], a[64:67], v[104:107], v[0:15]
    v_mfma_f32_32x32x16_bf16 v[0:15], a[80:83], v[108:111], v[0:15]
    v_mfma_f32_32x32x16_bf16 v[16:31], a[68:71], v[104:107], v[16:31]
    v_mfma_f32_32x32x16_bf16 v[16:31], a[84:87], v[108:111], v[16:31]
    v_mfma_f32_32x32x16_bf16 v[32:47], a[72:75], v[104:107], v[32:47]
    v_mfma_f32_32x32x16_bf16 v[32:47], a[88:91], v[108:111], v[32:47]
    v_mfma_f32_32x32x16_bf16 v[48:63], a[76:79], v[104:107], v[48:63]
    s_nop 0
    v_rcp_f32 v228, v228
    v_mfma_f32_32x32x16_bf16 v[48:63], a[92:95], v[108:111], v[48:63]
    s_nop 3
    v_pk_mul_f32 v[0:1], v[0:1], v[228:229] op_sel_hi:[1,0]
    v_pk_mul_f32 v[2:3], v[2:3], v[228:229] op_sel_hi:[1,0]
    v_pk_mul_f32 v[4:5], v[4:5], v[228:229] op_sel_hi:[1,0]
    v_pk_mul_f32 v[6:7], v[6:7], v[228:229] op_sel_hi:[1,0]
    v_cvt_pk_bf16_f32 v64, v0, v1
    v_cvt_pk_bf16_f32 v65, v2, v3
    v_cvt_pk_bf16_f32 v66, v4, v5
    v_cvt_pk_bf16_f32 v67, v6, v7
    buffer_store_dwordx4 v[64:67], v223, s[24:27], s68 offen offset:0 sc1
    v_pk_mul_f32 v[8:9], v[8:9], v[228:229] op_sel_hi:[1,0]
    v_pk_mul_f32 v[10:11], v[10:11], v[228:229] op_sel_hi:[1,0]
    v_pk_mul_f32 v[12:13], v[12:13], v[228:229] op_sel_hi:[1,0]
    v_pk_mul_f32 v[14:15], v[14:15], v[228:229] op_sel_hi:[1,0]
    v_cvt_pk_bf16_f32 v68, v8, v9
    v_cvt_pk_bf16_f32 v69, v10, v11
    v_cvt_pk_bf16_f32 v70, v12, v13
    v_cvt_pk_bf16_f32 v71, v14, v15
    buffer_store_dwordx4 v[68:71], v223, s[24:27], s68 offen offset:1024 sc1
    v_pk_mul_f32 v[16:17], v[16:17], v[228:229] op_sel_hi:[1,0]
    v_pk_mul_f32 v[18:19], v[18:19], v[228:229] op_sel_hi:[1,0]
    v_pk_mul_f32 v[20:21], v[20:21], v[228:229] op_sel_hi:[1,0]
    v_pk_mul_f32 v[22:23], v[22:23], v[228:229] op_sel_hi:[1,0]
    v_cvt_pk_bf16_f32 v72, v16, v17
    v_cvt_pk_bf16_f32 v73, v18, v19
    v_cvt_pk_bf16_f32 v74, v20, v21
    v_cvt_pk_bf16_f32 v75, v22, v23
    buffer_store_dwordx4 v[72:75], v223, s[24:27], s68 offen offset:2048 sc1
    v_pk_mul_f32 v[24:25], v[24:25], v[228:229] op_sel_hi:[1,0]
    v_pk_mul_f32 v[26:27], v[26:27], v[228:229] op_sel_hi:[1,0]
    v_pk_mul_f32 v[28:29], v[28:29], v[228:229] op_sel_hi:[1,0]
    v_pk_mul_f32 v[30:31], v[30:31], v[228:229] op_sel_hi:[1,0]
    v_cvt_pk_bf16_f32 v76, v24, v25
    v_cvt_pk_bf16_f32 v77, v26, v27
    v_cvt_pk_bf16_f32 v78, v28, v29
    v_cvt_pk_bf16_f32 v79, v30, v31
    buffer_store_dwordx4 v[76:79], v223, s[24:27], s68 offen offset:3072 sc1
    v_pk_mul_f32 v[32:33], v[32:33], v[228:229] op_sel_hi:[1,0]
    v_pk_mul_f32 v[34:35], v[34:35], v[228:229] op_sel_hi:[1,0]
    v_pk_mul_f32 v[36:37], v[36:37], v[228:229] op_sel_hi:[1,0]
    v_pk_mul_f32 v[38:39], v[38:39], v[228:229] op_sel_hi:[1,0]
    v_cvt_pk_bf16_f32 v80, v32, v33
    v_cvt_pk_bf16_f32 v81, v34, v35
    v_cvt_pk_bf16_f32 v82, v36, v37
    v_cvt_pk_bf16_f32 v83, v38, v39
    buffer_store_dwordx4 v[80:83], v224, s[24:27], s68 offen offset:0 sc1
    v_pk_mul_f32 v[40:41], v[40:41], v[228:229] op_sel_hi:[1,0]
    v_pk_mul_f32 v[42:43], v[42:43], v[228:229] op_sel_hi:[1,0]
    v_pk_mul_f32 v[44:45], v[44:45], v[228:229] op_sel_hi:[1,0]
    v_pk_mul_f32 v[46:47], v[46:47], v[228:229] op_sel_hi:[1,0]
    v_cvt_pk_bf16_f32 v84, v40, v41
    v_cvt_pk_bf16_f32 v85, v42, v43
    v_cvt_pk_bf16_f32 v86, v44, v45
    v_cvt_pk_bf16_f32 v87, v46, v47
    buffer_store_dwordx4 v[84:87], v224, s[24:27], s68 offen offset:1024 sc1
    v_pk_mul_f32 v[48:49], v[48:49], v[228:229] op_sel_hi:[1,0]
    v_pk_mul_f32 v[50:51], v[50:51], v[228:229] op_sel_hi:[1,0]
    v_pk_mul_f32 v[52:53], v[52:53], v[228:229] op_sel_hi:[1,0]
    v_pk_mul_f32 v[54:55], v[54:55], v[228:229] op_sel_hi:[1,0]
    v_cvt_pk_bf16_f32 v88, v48, v49
    v_cvt_pk_bf16_f32 v89, v50, v51
    v_cvt_pk_bf16_f32 v90, v52, v53
    v_cvt_pk_bf16_f32 v91, v54, v55
    buffer_store_dwordx4 v[88:91], v224, s[24:27], s68 offen offset:2048 sc1
    v_pk_mul_f32 v[56:57], v[56:57], v[228:229] op_sel_hi:[1,0]
    v_pk_mul_f32 v[58:59], v[58:59], v[228:229] op_sel_hi:[1,0]
    v_pk_mul_f32 v[60:61], v[60:61], v[228:229] op_sel_hi:[1,0]
    v_pk_mul_f32 v[62:63], v[62:63], v[228:229] op_sel_hi:[1,0]
    v_cvt_pk_bf16_f32 v92, v56, v57
    v_cvt_pk_bf16_f32 v93, v58, v59
    v_cvt_pk_bf16_f32 v94, v60, v61
    v_cvt_pk_bf16_f32 v95, v62, v63
    buffer_store_dwordx4 v[92:95], v224, s[24:27], s68 offen offset:3072 sc1
    s_add_u32 s68, s68, 0x8000
    s_setpc_b64 s[40:41]
LAP3:
    s_waitcnt vmcnt(24) lgkmcnt(0)
    v_mfma_f32_32x32x16_bf16 v[0:15], a[64:67], v[96:99], v[0:15]
    s_barrier
    v_add_u32 v192, s45, v204
    v_xor_b32 v193, 32, v192
    v_xor_b32 v194, 64, v192
    v_xor_b32 v195, 96, v192
    v_mfma_f32_32x32x16_bf16 v[16:31], a[68:71], v[96:99], v[16:31]
    ds_read_b128 a[32:35], v192 offset:0
    ds_read_b128 a[36:39], v193 offset:0
    v_xor_b32 v196, 128, v192
    v_xor_b32 v197, 160, v192
    v_exp_f32 v232, v80
    v_mfma_f32_32x32x16_bf16 v[32:47], a[72:75], v[96:99], v[32:47]
    ds_read_b128 a[40:43], v194 offset:0
    ds_read_b128 a[44:47], v195 offset:0
    v_xor_b32 v198, 192, v192
    v_xor_b32 v199, 224, v192
    v_exp_f32 v233, v81
    v_mfma_f32_32x32x16_bf16 v[48:63], a[76:79], v[96:99], v[48:63]
    ds_read_b128 a[48:51], v196 offset:0
    ds_read_b128 a[52:55], v197 offset:0
    v_exp_f32 v234, v82
    v_cvt_pk_bf16_f32 v104, v232, v233
    v_mfma_f32_32x32x16_bf16 v[0:15], a[80:83], v[100:103], v[0:15]
    ds_read_b128 a[56:59], v198 offset:0
    ds_read_b128 a[60:63], v199 offset:0
    v_exp_f32 v235, v83
    v_exp_f32 v232, v84
    v_mfma_f32_16x16x32_bf16 v[228:231], a[168:171], v[96:99], v[228:231]
    v_add_u32 v200, s45, v205
    v_xor_b32 v201, 64, v200
    v_mfma_f32_32x32x16_bf16 v[16:31], a[84:87], v[100:103], v[16:31]
    buffer_load_dwordx4 v219, s[20:23], s55 offen offset:0 lds
    v_cvt_pk_bf16_f32 v105, v234, v235
    v_exp_f32 v233, v85
    v_mfma_f32_32x32x16_bf16 v[32:47], a[88:91], v[100:103], v[32:47]
    v_exp_f32 v234, v86
    v_cvt_pk_bf16_f32 v106, v232, v233
    v_exp_f32 v235, v87
    v_or3_b32 v226, v104, v105, v106
    v_mfma_f32_16x16x32_bf16 v[228:231], a[168:171], v[100:103], v[228:231]
    v_xor_b32 v202, 128, v200
    v_xor_b32 v203, 192, v200
    v_mfma_f32_32x32x16_bf16 v[48:63], a[92:95], v[100:103], v[48:63]
    buffer_load_dwordx4 v220, s[20:23], s55 offen offset:1024 lds
    v_exp_f32 v232, v88
    v_cvt_pk_bf16_f32 v107, v234, v235
    s_waitcnt lgkmcnt(0)
    v_mfma_f32_32x32x16_bf16 v[64:79], a[32:35], a[0:3], v[112:127]
    ds_read_b64_tr_b16 a[64:65], v200 offset:18432
    ds_read_b64_tr_b16 a[66:67], v200 offset:22528
    ds_read_b64_tr_b16 a[68:69], v201 offset:18432
    v_exp_f32 v233, v89
    v_mfma_f32_32x32x16_bf16 v[64:79], a[36:39], a[4:7], v[64:79]
    ds_read_b64_tr_b16 a[70:71], v201 offset:22528
    ds_read_b64_tr_b16 a[72:73], v202 offset:18432
    ds_read_b64_tr_b16 a[74:75], v202 offset:22528
    v_exp_f32 v234, v90
    v_cvt_pk_bf16_f32 v108, v232, v233
    v_mfma_f32_32x32x16_bf16 v[64:79], a[40:43], a[8:11], v[64:79]
    ds_read_b64_tr_b16 a[76:77], v203 offset:18432
    ds_read_b64_tr_b16 a[78:79], v203 offset:22528
    ds_read_b64_tr_b16 a[80:81], v200 offset:26624
    v_exp_f32 v235, v91
    v_or3_b32 v226, v226, v107, v108
    v_mfma_f32_32x32x16_bf16 v[64:79], a[44:47], a[12:15], v[64:79]
    ds_read_b64_tr_b16 a[82:83], v200 offset:30720
    ds_read_b64_tr_b16 a[84:85], v201 offset:26624
    ds_read_b64_tr_b16 a[86:87], v201 offset:30720
    v_exp_f32 v232, v92
    v_cvt_pk_bf16_f32 v109, v234, v235
    v_mfma_f32_32x32x16_bf16 v[64:79], a[48:51], a[16:19], v[64:79]
    ds_read_b64_tr_b16 a[88:89], v202 offset:26624
    ds_read_b64_tr_b16 a[90:91], v202 offset:30720
    v_exp_f32 v233, v93
    v_mfma_f32_32x32x16_bf16 v[64:79], a[52:55], a[20:23], v[64:79]
    ds_read_b64_tr_b16 a[92:93], v203 offset:26624
    ds_read_b64_tr_b16 a[94:95], v203 offset:30720
    buffer_load_dwordx4 v221, s[20:23], s55 offen offset:2048 lds
    v_exp_f32 v234, v94
    v_cvt_pk_bf16_f32 v110, v232, v233
    v_mfma_f32_32x32x16_bf16 v[64:79], a[56:59], a[24:27], v[64:79]
    v_exp_f32 v235, v95
    v_or3_b32 v226, v226, v109, v110
    v_cvt_pk_bf16_f32 v111, v234, v235
    v_bitop3_b32 v226, v226, s65, v111 bitop3:0xc8
    v_cmp_ne_u32 vcc, 0, v226
    v_mfma_f32_32x32x16_bf16 v[64:79], a[60:63], a[28:31], v[64:79]
    buffer_load_dwordx4 v222, s[20:23], s55 offen offset:3072 lds
    s_cbranch_vccnz Ltr_32
Lbk_33:
    s_waitcnt lgkmcnt(0)
    v_mfma_f32_32x32x16_bf16 v[0:15], a[64:67], v[104:107], v[0:15]
    ds_read_b128 a[32:35], v192 offset:2048
    ds_read_b128 a[36:39], v193 offset:2048
    s_add_u32 m0, m0, 0x4000
    v_mfma_f32_32x32x16_bf16 v[16:31], a[68:71], v[104:107], v[16:31]
    ds_read_b128 a[40:43], v194 offset:2048
    ds_read_b128 a[44:47], v195 offset:2048
    v_exp_f32 v232, v64
    v_mfma_f32_32x32x16_bf16 v[32:47], a[72:75], v[104:107], v[32:47]
    ds_read_b128 a[48:51], v196 offset:2048
    ds_read_b128 a[52:55], v197 offset:2048
    v_exp_f32 v233, v65
    v_exp_f32 v234, v66
    v_mfma_f32_32x32x16_bf16 v[48:63], a[76:79], v[104:107], v[48:63]
    ds_read_b128 a[56:59], v198 offset:2048
    ds_read_b128 a[60:63], v199 offset:2048
    v_cvt_pk_bf16_f32 v96, v232, v233
    v_exp_f32 v235, v67
    v_mfma_f32_32x32x16_bf16 v[0:15], a[80:83], v[108:111], v[0:15]
    v_exp_f32 v232, v68
    v_cvt_pk_bf16_f32 v97, v234, v235
    v_exp_f32 v233, v69
    v_mfma_f32_16x16x32_bf16 v[228:231], a[168:171], v[104:107], v[228:231]
    s_add_u32 s46, s45, s44
    s_add_u32 s45, s45, 0x8000
    v_mfma_f32_32x32x16_bf16 v[16:31], a[84:87], v[108:111], v[16:31]
    buffer_load_dwordx4 v219, s[20:23], s56 offen offset:0 lds
    v_exp_f32 v234, v70
    v_cvt_pk_bf16_f32 v98, v232, v233
    v_mfma_f32_32x32x16_bf16 v[32:47], a[88:91], v[108:111], v[32:47]
    v_exp_f32 v235, v71
    v_or3_b32 v226, v96, v97, v98
    v_exp_f32 v232, v72
    v_cvt_pk_bf16_f32 v99, v234, v235
    v_mfma_f32_16x16x32_bf16 v[228:231], a[168:171], v[108:111], v[228:231]
    s_cmp_eq_u32 s45, s76
    s_cselect_b32 s45, 0, s45
    v_mfma_f32_32x32x16_bf16 v[48:63], a[92:95], v[108:111], v[48:63]
    buffer_load_dwordx4 v220, s[20:23], s56 offen offset:1024 lds
    v_exp_f32 v233, v73
    s_waitcnt lgkmcnt(0)
    v_mfma_f32_32x32x16_bf16 v[80:95], a[32:35], a[0:3], v[112:127]
    ds_read_b64_tr_b16 a[64:65], v200 offset:16384
    ds_read_b64_tr_b16 a[66:67], v200 offset:20480
    ds_read_b64_tr_b16 a[68:69], v201 offset:16384
    v_exp_f32 v234, v74
    v_cvt_pk_bf16_f32 v100, v232, v233
    v_mfma_f32_32x32x16_bf16 v[80:95], a[36:39], a[4:7], v[80:95]
    ds_read_b64_tr_b16 a[70:71], v201 offset:20480
    ds_read_b64_tr_b16 a[72:73], v202 offset:16384
    ds_read_b64_tr_b16 a[74:75], v202 offset:20480
    v_exp_f32 v235, v75
    v_or3_b32 v226, v226, v99, v100
    v_mfma_f32_32x32x16_bf16 v[80:95], a[40:43], a[8:11], v[80:95]
    ds_read_b64_tr_b16 a[76:77], v203 offset:16384
    ds_read_b64_tr_b16 a[78:79], v203 offset:20480
    ds_read_b64_tr_b16 a[80:81], v200 offset:24576
    v_exp_f32 v232, v76
    v_mfma_f32_32x32x16_bf16 v[80:95], a[44:47], a[12:15], v[80:95]
    ds_read_b64_tr_b16 a[82:83], v200 offset:28672
    ds_read_b64_tr_b16 a[84:85], v201 offset:24576
    ds_read_b64_tr_b16 a[86:87], v201 offset:28672
    v_cvt_pk_bf16_f32 v101, v234, v235
    v_mfma_f32_32x32x16_bf16 v[80:95], a[48:51], a[16:19], v[80:95]
    ds_read_b64_tr_b16 a[88:89], v202 offset:24576
    ds_read_b64_tr_b16 a[90:91], v202 offset:28672
    v_exp_f32 v233, v77
    v_exp_f32 v234, v78
    v_mfma_f32_32x32x16_bf16 v[80:95], a[52:55], a[20:23], v[80:95]
    ds_read_b64_tr_b16 a[92:93], v203 offset:24576
    ds_read_b64_tr_b16 a[94:95], v203 offset:28672
    buffer_load_dwordx4 v221, s[20:23], s56 offen offset:2048 lds
    v_cvt_pk_bf16_f32 v102, v232, v233
    v_exp_f32 v235, v79
    v_mfma_f32_32x32x16_bf16 v[80:95], a[56:59], a[24:27], v[80:95]
    v_or3_b32 v226, v226, v101, v102
    v_cvt_pk_bf16_f32 v103, v234, v235
    v_bitop3_b32 v226, v226, s64, v103 bitop3:0xc8
    v_cmp_ne_u32 vcc, s63, v226
    v_mfma_f32_32x32x16_bf16 v[80:95], a[60:63], a[28:31], v[80:95]
    buffer_load_dwordx4 v222, s[20:23], s56 offen offset:3072 lds
    s_add_u32 s54, s54, 0x100000
    s_xor_b32 s55, s54, s57
    s_add_u32 s56, s55, 0x80000
    s_mov_b32 m0, s46
    s_sub_u32 s47, s47, 1
    s_cbranch_vccnz Ltr_34
Lbk_35:
    s_cbranch_scc0 LAP3
    s_setpc_b64 s[40:41]
LAP7:
    s_waitcnt vmcnt(56) lgkmcnt(0)
    v_mfma_f32_32x32x16_bf16 v[0:15], a[64:67], v[96:99], v[0:15]
    s_barrier
    v_add_u32 v192, s45, v204
    v_xor_b32 v193, 32, v192
    v_xor_b32 v194, 64, v192
    v_xor_b32 v195, 96, v192
    v_mfma_f32_32x32x16_bf16 v[16:31], a[68:71], v[96:99], v[16:31]
    ds_read_b128 a[32:35], v192 offset:0
    ds_read_b128 a[36:39], v193 offset:0
    v_xor_b32 v196, 128, v192
    v_xor_b32 v197, 160, v192
    v_exp_f32 v232, v80
    v_mfma_f32_32x32x16_bf16 v[32:47], a[72:75], v[96:99], v[32:47]
    ds_read_b128 a[40:43], v194 offset:0
    ds_read_b128 a[44:47], v195 offset:0
    v_xor_b32 v198, 192, v192
    v_xor_b32 v199, 224, v192
    v_exp_f32 v233, v81
    v_mfma_f32_32x32x16_bf16 v[48:63], a[76:79], v[96:99], v[48:63]
    ds_read_b128 a[48:51], v196 offset:0
    ds_read_b128 a[52:55], v197 offset:0
    v_exp_f32 v234, v82
    v_cvt_pk_bf16_f32 v104, v232, v233
    v_mfma_f32_32x32x16_bf16 v[0:15], a[80:83], v[100:103], v[0:15]
    ds_read_b128 a[56:59], v198 offset:0
    ds_read_b128 a[60:63], v199 offset:0
    v_exp_f32 v235, v83
    v_mfma_f32_16x16x32_bf16 v[228:231], a[168:171], v[96:99], v[228:231]
    v_add_u32 v200, s45, v205
    v_xor_b32 v201, 64, v200
    v_mfma_f32_32x32x16_bf16 v[16:31], a[84:87], v[100:103], v[16:31]
    v_exp_f32 v232, v84
    v_cvt_pk_bf16_f32 v105, v234, v235
    v_exp_f32 v233, v85
    v_mfma_f32_32x32x16_bf16 v[32:47], a[88:91], v[100:103], v[32:47]
    v_exp_f32 v234, v86
    v_cvt_pk_bf16_f32 v106, v232, v233
    v_exp_f32 v235, v87
    v_or3_b32 v226, v104, v105, v106
    v_mfma_f32_16x16x32_bf16 v[228:231], a[168:171], v[100:103], v[228:231]
    v_xor_b32 v202, 128, v200
    v_xor_b32 v203, 192, v200
    v_mfma_f32_32x32x16_bf16 v[48:63], a[92:95], v[100:103], v[48:63]
    v_exp_f32 v232, v88
    v_cvt_pk_bf16_f32 v107, v234, v235
    s_waitcnt lgkmcnt(0)
    v_mfma_f32_32x32x16_bf16 v[64:79], a[32:35], a[0:3], v[112:127]
    ds_read_b64_tr_b16 a[64:65], v200 offset:18432
    ds_read_b64_tr_b16 a[66:67], v200 offset:22528
    ds_read_b64_tr_b16 a[68:69], v201 offset:18432
    v_exp_f32 v233, v89
    v_mfma_f32_32x32x16_bf16 v[64:79], a[36:39], a[4:7], v[64:79]
    ds_read_b64_tr_b16 a[70:71], v201 offset:22528
    ds_read_b64_tr_b16 a[72:73], v202 offset:18432
    ds_read_b64_tr_b16 a[74:75], v202 offset:22528
    v_exp_f32 v234, v90
    v_cvt_pk_bf16_f32 v108, v232, v233
    v_mfma_f32_32x32x16_bf16 v[64:79], a[40:43], a[8:11], v[64:79]
    ds_read_b64_tr_b16 a[76:77], v203 offset:18432
    ds_read_b64_tr_b16 a[78:79], v203 offset:22528
    ds_read_b64_tr_b16 a[80:81], v200 offset:26624
    v_exp_f32 v235, v91
    v_or3_b32 v226, v226, v107, v108
    v_mfma_f32_32x32x16_bf16 v[64:79], a[44:47], a[12:15], v[64:79]
    ds_read_b64_tr_b16 a[82:83], v200 offset:30720
    ds_read_b64_tr_b16 a[84:85], v201 offset:26624
    ds_read_b64_tr_b16 a[86:87], v201 offset:30720
    v_exp_f32 v232, v92
    v_cvt_pk_bf16_f32 v109, v234, v235
    v_mfma_f32_32x32x16_bf16 v[64:79], a[48:51], a[16:19], v[64:79]
    ds_read_b64_tr_b16 a[88:89], v202 offset:26624
    ds_read_b64_tr_b16 a[90:91], v202 offset:30720
    v_exp_f32 v233, v93
    v_mfma_f32_32x32x16_bf16 v[64:79], a[52:55], a[20:23], v[64:79]
    ds_read_b64_tr_b16 a[92:93], v203 offset:26624
    ds_read_b64_tr_b16 a[94:95], v203 offset:30720
    v_exp_f32 v234, v94
    v_cvt_pk_bf16_f32 v110, v232, v233
    v_mfma_f32_32x32x16_bf16 v[64:79], a[56:59], a[24:27], v[64:79]
    v_exp_f32 v235, v95
    v_or3_b32 v226, v226, v109, v110
    v_cvt_pk_bf16_f32 v111, v234, v235
    v_bitop3_b32 v226, v226, s65, v111 bitop3:0xc8
    v_cmp_ne_u32 vcc, 0, v226
    v_mfma_f32_32x32x16_bf16 v[64:79], a[60:63], a[28:31], v[64:79]
    s_cbranch_vccnz Ltr_36
Lbk_37:
    s_waitcnt lgkmcnt(0)
    v_mfma_f32_32x32x16_bf16 v[0:15], a[64:67], v[104:107], v[0:15]
    ds_read_b128 a[32:35], v192 offset:2048
    ds_read_b128 a[36:39], v193 offset:2048
    v_mfma_f32_32x32x16_bf16 v[16:31], a[68:71], v[104:107], v[16:31]
    ds_read_b128 a[40:43], v194 offset:2048
    ds_read_b128 a[44:47], v195 offset:2048
    buffer_load_dwordx4 v219, s[20:23], s55 offen offset:0 lds
    v_exp_f32 v232, v64
    v_mfma_f32_32x32x16_bf16 v[32:47], a[72:75], v[104:107], v[32:47]
    ds_read_b128 a[48:51], v196 offset:2048
    ds_read_b128 a[52:55], v197 offset:2048
    v_exp_f32 v233, v65
    v_exp_f32 v234, v66
    v_mfma_f32_32x32x16_bf16 v[48:63], a[76:79], v[104:107], v[48:63]
    ds_read_b128 a[56:59], v198 offset:2048
    ds_read_b128 a[60:63], v199 offset:2048
    buffer_load_dwordx4 v220, s[20:23], s55 offen offset:1024 lds
    v_cvt_pk_bf16_f32 v96, v232, v233
    v_exp_f32 v235, v67
    v_mfma_f32_32x32x16_bf16 v[0:15], a[80:83], v[108:111], v[0:15]
    v_exp_f32 v232, v68
    v_cvt_pk_bf16_f32 v97, v234, v235
    v_exp_f32 v233, v69
    v_mfma_f32_16x16x32_bf16 v[228:231], a[168:171], v[104:107], v[228:231]
    s_add_u32 s46, s45, s44
    s_add_u32 s45, s45, 0x8000
    v_mfma_f32_32x32x16_bf16 v[16:31], a[84:87], v[108:111], v[16:31]
    buffer_load_dwordx4 v221, s[20:23], s55 offen offset:2048 lds
    v_exp_f32 v234, v70
    v_cvt_pk_bf16_f32 v98, v232, v233
    v_mfma_f32_32x32x16_bf16 v[32:47], a[88:91], v[108:111], v[32:47]
    v_exp_f32 v235, v71
    v_or3_b32 v226, v96, v97, v98
    v_exp_f32 v232, v72
    v_cvt_pk_bf16_f32 v99, v234, v235
    v_mfma_f32_16x16x32_bf16 v[228:231], a[168:171], v[108:111], v[228:231]
    s_cmp_eq_u32 s45, s76
    s_cselect_b32 s45, 0, s45
    v_mfma_f32_32x32x16_bf16 v[48:63], a[92:95], v[108:111], v[48:63]
    buffer_load_dwordx4 v222, s[20:23], s55 offen offset:3072 lds
    v_exp_f32 v233, v73
    s_add_u32 m0, m0, 0x4000
    s_waitcnt lgkmcnt(0)
    v_mfma_f32_32x32x16_bf16 v[80:95], a[32:35], a[0:3], v[112:127]
    ds_read_b64_tr_b16 a[64:65], v200 offset:16384
    ds_read_b64_tr_b16 a[66:67], v200 offset:20480
    ds_read_b64_tr_b16 a[68:69], v201 offset:16384
    v_exp_f32 v234, v74
    v_cvt_pk_bf16_f32 v100, v232, v233
    v_mfma_f32_32x32x16_bf16 v[80:95], a[36:39], a[4:7], v[80:95]
    ds_read_b64_tr_b16 a[70:71], v201 offset:20480
    ds_read_b64_tr_b16 a[72:73], v202 offset:16384
    ds_read_b64_tr_b16 a[74:75], v202 offset:20480
    v_exp_f32 v235, v75
    v_or3_b32 v226, v226, v99, v100
    v_mfma_f32_32x32x16_bf16 v[80:95], a[40:43], a[8:11], v[80:95]
    ds_read_b64_tr_b16 a[76:77], v203 offset:16384
    ds_read_b64_tr_b16 a[78:79], v203 offset:20480
    ds_read_b64_tr_b16 a[80:81], v200 offset:24576
    buffer_load_dwordx4 v219, s[20:23], s56 offen offset:0 lds
    v_exp_f32 v232, v76
    v_mfma_f32_32x32x16_bf16 v[80:95], a[44:47], a[12:15], v[80:95]
    ds_read_b64_tr_b16 a[82:83], v200 offset:28672
    ds_read_b64_tr_b16 a[84:85], v201 offset:24576
    ds_read_b64_tr_b16 a[86:87], v201 offset:28672
    v_cvt_pk_bf16_f32 v101, v234, v235
    v_mfma_f32_32x32x16_bf16 v[80:95], a[48:51], a[16:19], v[80:95]
    ds_read_b64_tr_b16 a[88:89], v202 offset:24576
    ds_read_b64_tr_b16 a[90:91], v202 offset:28672
    buffer_load_dwordx4 v220, s[20:23], s56 offen offset:1024 lds
    v_exp_f32 v233, v77
    v_mfma_f32_32x32x16_bf16 v[80:95], a[52:55], a[20:23], v[80:95]
    ds_read_b64_tr_b16 a[92:93], v203 offset:24576
    ds_read_b64_tr_b16 a[94:95], v203 offset:28672
    v_exp_f32 v234, v78
    v_cvt_pk_bf16_f32 v102, v232, v233
    v_mfma_f32_32x32x16_bf16 v[80:95], a[56:59], a[24:27], v[80:95]
    buffer_load_dwordx4 v221, s[20:23], s56 offen offset:2048 lds
    v_exp_f32 v235, v79
    v_or3_b32 v226, v226, v101, v102
    v_cvt_pk_bf16_f32 v103, v234, v235
    v_bitop3_b32 v226, v226, s64, v103 bitop3:0xc8
    v_cmp_ne_u32 vcc, s63, v226
    v_mfma_f32_32x32x16_bf16 v[80:95], a[60:63], a[28:31], v[80:95]
    buffer_load_dwordx4 v222, s[20:23], s56 offen offset:3072 lds
    s_add_u32 s54, s54, 0x100000
    s_xor_b32 s55, s54, s57
    s_add_u32 s56, s55, 0x80000
    s_mov_b32 m0, s46
    s_sub_u32 s47, s47, 1
    s_cbranch_vccnz Ltr_38
Lbk_39:
    s_cbranch_scc0 LAP7
    s_setpc_b64 s[40:41]
LPP4:
    v_add_u32 v192, s45, v208
    v_xor_b32 v193, 64, v192
    s_waitcnt vmcnt(41) lgkmcnt(0)
    s_barrier
    ds_read_b64_tr_b16 a[128:129], v192 offset:0
    ds_read_b64_tr_b16 a[130:131], v192 offset:1024
    ds_read_b64_tr_b16 a[132:133], v193 offset:0
    ds_read_b64_tr_b16 a[134:135], v193 offset:1024
    ds_read_b64_tr_b16 a[136:137], v192 offset:2048
    ds_read_b64_tr_b16 a[138:139], v192 offset:3072
    ds_read_b64_tr_b16 a[140:141], v193 offset:2048
    ds_read_b64_tr_b16 a[142:143], v193 offset:3072
    s_waitcnt vmcnt(22) lgkmcnt(4)
    v_mfma_f32_32x32x16_bf16 a[96:111], a[128:131], v[128:131], a[96:111]
    ds_read_b64_tr_b16 a[144:145], v192 offset:4096
    ds_read_b64_tr_b16 a[146:147], v192 offset:5120
    ds_read_b64_tr_b16 a[148:149], v193 offset:4096
    v_mfma_f32_32x32x16_bf16 a[112:127], a[132:135], v[128:131], a[112:127]
    ds_read_b64_tr_b16 a[150:151], v193 offset:5120
    ds_read_b64_tr_b16 a[152:153], v192 offset:6144
    ds_read_b64_tr_b16 a[154:155], v192 offset:7168
    s_waitcnt lgkmcnt(6)
    v_mfma_f32_32x32x16_bf16 a[96:111], a[136:139], v[132:135], a[96:111]
    ds_read_b64_tr_b16 a[156:157], v193 offset:6144
    ds_read_b64_tr_b16 a[158:159], v193 offset:7168
    buffer_load_dwordx4 v[128:131], v223, s[28:31], s59 offen offset:0 sc1
    v_mfma_f32_32x32x16_bf16 a[112:127], a[140:143], v[132:135], a[112:127]
    buffer_load_dwordx4 v219, s[20:23], s55 offen offset:0 lds
    buffer_load_dwordx4 v[132:135], v223, s[28:31], s59 offen offset:1024 sc1
    s_waitcnt vmcnt(23) lgkmcnt(4)
    v_mfma_f32_32x32x16_bf16 a[96:111], a[144:147], v[136:139], a[96:111]
    ds_read_b64_tr_b16 a[128:129], v192 offset:8192
    ds_read_b64_tr_b16 a[130:131], v192 offset:9216
    ds_read_b64_tr_b16 a[132:133], v193 offset:8192
    v_mfma_f32_32x32x16_bf16 a[112:127], a[148:151], v[136:139], a[112:127]
    ds_read_b64_tr_b16 a[134:135], v193 offset:9216
    ds_read_b64_tr_b16 a[136:137], v192 offset:10240
    ds_read_b64_tr_b16 a[138:139], v192 offset:11264
    s_waitcnt lgkmcnt(6)
    v_mfma_f32_32x32x16_bf16 a[96:111], a[152:155], v[140:143], a[96:111]
    ds_read_b64_tr_b16 a[140:141], v193 offset:10240
    ds_read_b64_tr_b16 a[142:143], v193 offset:11264
    buffer_load_dwordx4 v[136:139], v223, s[28:31], s59 offen offset:2048 sc1
    v_mfma_f32_32x32x16_bf16 a[112:127], a[156:159], v[140:143], a[112:127]
    buffer_load_dwordx4 v220, s[20:23], s55 offen offset:1024 lds
    buffer_load_dwordx4 v[140:143], v223, s[28:31], s59 offen offset:3072 sc1
    s_waitcnt vmcnt(24) lgkmcnt(4)
    v_mfma_f32_32x32x16_bf16 a[96:111], a[128:131], v[144:147], a[96:111]
    ds_read_b64_tr_b16 a[144:145], v192 offset:12288
    ds_read_b64_tr_b16 a[146:147], v192 offset:13312
    ds_read_b64_tr_b16 a[148:149], v193 offset:12288
    v_mfma_f32_32x32x16_bf16 a[112:127], a[132:135], v[144:147], a[112:127]
    ds_read_b64_tr_b16 a[150:151], v193 offset:13312
    ds_read_b64_tr_b16 a[152:153], v192 offset:14336
    ds_read_b64_tr_b16 a[154:155], v192 offset:15360
    s_waitcnt lgkmcnt(6)
    v_mfma_f32_32x32x16_bf16 a[96:111], a[136:139], v[148:151], a[96:111]
    ds_read_b64_tr_b16 a[156:157], v193 offset:14336
    ds_read_b64_tr_b16 a[158:159], v193 offset:15360
    buffer_load_dwordx4 v[144:147], v224, s[28:31], s59 offen offset:0 sc1
    v_mfma_f32_32x32x16_bf16 a[112:127], a[140:143], v[148:151], a[112:127]
    buffer_load_dwordx4 v221, s[20:23], s55 offen offset:2048 lds
    buffer_load_dwordx4 v[148:151], v224, s[28:31], s59 offen offset:1024 sc1
    s_waitcnt vmcnt(25) lgkmcnt(4)
    v_mfma_f32_32x32x16_bf16 a[96:111], a[144:147], v[152:155], a[96:111]
    ds_read_b64_tr_b16 a[128:129], v192 offset:16384
    ds_read_b64_tr_b16 a[130:131], v192 offset:17408
    ds_read_b64_tr_b16 a[132:133], v193 offset:16384
    v_mfma_f32_32x32x16_bf16 a[112:127], a[148:151], v[152:155], a[112:127]
    ds_read_b64_tr_b16 a[134:135], v193 offset:17408
    ds_read_b64_tr_b16 a[136:137], v192 offset:18432
    ds_read_b64_tr_b16 a[138:139], v192 offset:19456
    s_waitcnt lgkmcnt(6)
    v_mfma_f32_32x32x16_bf16 a[96:111], a[152:155], v[156:159], a[96:111]
    ds_read_b64_tr_b16 a[140:141], v193 offset:18432
    ds_read_b64_tr_b16 a[142:143], v193 offset:19456
    buffer_load_dwordx4 v[152:155], v224, s[28:31], s59 offen offset:2048 sc1
    v_mfma_f32_32x32x16_bf16 a[112:127], a[156:159], v[156:159], a[112:127]
    buffer_load_dwordx4 v222, s[20:23], s55 offen offset:3072 lds
    buffer_load_dwordx4 v[156:159], v224, s[28:31], s59 offen offset:3072 sc1
    s_add_u32 m0, m0, 0x4000
    s_waitcnt vmcnt(26) lgkmcnt(4)
    v_mfma_f32_32x32x16_bf16 a[96:111], a[128:131], v[160:163], a[96:111]
    ds_read_b64_tr_b16 a[144:145], v192 offset:20480
    ds_read_b64_tr_b16 a[146:147], v192 offset:21504
    ds_read_b64_tr_b16 a[148:149], v193 offset:20480
    v_mfma_f32_32x32x16_bf16 a[112:127], a[132:135], v[160:163], a[112:127]
    ds_read_b64_tr_b16 a[150:151], v193 offset:21504
    ds_read_b64_tr_b16 a[152:153], v192 offset:22528
    ds_read_b64_tr_b16 a[154:155], v192 offset:23552
    s_waitcnt lgkmcnt(6)
    v_mfma_f32_32x32x16_bf16 a[96:111], a[136:139], v[164:167], a[96:111]
    ds_read_b64_tr_b16 a[156:157], v193 offset:22528
    ds_read_b64_tr_b16 a[158:159], v193 offset:23552
    buffer_load_dwordx4 v[160:163], v223, s[28:31], s60 offen offset:0 sc1
    v_mfma_f32_32x32x16_bf16 a[112:127], a[140:143], v[164:167], a[112:127]
    buffer_load_dwordx4 v219, s[20:23], s56 offen offset:0 lds
    buffer_load_dwordx4 v[164:167], v223, s[28:31], s60 offen offset:1024 sc1
    s_waitcnt vmcnt(27) lgkmcnt(4)
    v_mfma_f32_32x32x16_bf16 a[96:111], a[144:147], v[168:171], a[96:111]
    ds_read_b64_tr_b16 a[128:129], v192 offset:24576
    ds_read_b64_tr_b16 a[130:131], v192 offset:25600
    ds_read_b64_tr_b16 a[132:133], v193 offset:24576
    v_mfma_f32_32x32x16_bf16 a[112:127], a[148:151], v[168:171], a[112:127]
    ds_read_b64_tr_b16 a[134:135], v193 offset:25600
    ds_read_b64_tr_b16 a[136:137], v192 offset:26624
    ds_read_b64_tr_b16 a[138:139], v192 offset:27648
    s_waitcnt lgkmcnt(6)
    v_mfma_f32_32x32x16_bf16 a[96:111], a[152:155], v[172:175], a[96:111]
    ds_read_b64_tr_b16 a[140:141], v193 offset:26624
    ds_read_b64_tr_b16 a[142:143], v193 offset:27648
    buffer_load_dwordx4 v[168:171], v223, s[28:31], s60 offen offset:2048 sc1
    v_mfma_f32_32x32x16_bf16 a[112:127], a[156:159], v[172:175], a[112:127]
    buffer_load_dwordx4 v220, s[20:23], s56 offen offset:1024 lds
    buffer_load_dwordx4 v[172:175], v223, s[28:31], s60 offen offset:3072 sc1
    s_waitcnt vmcnt(28) lgkmcnt(4)
    v_mfma_f32_32x32x16_bf16 a[96:111], a[128:131], v[176:179], a[96:111]
    ds_read_b64_tr_b16 a[144:145], v192 offset:28672
    ds_read_b64_tr_b16 a[146:147], v192 offset:29696
    ds_read_b64_tr_b16 a[148:149], v193 offset:28672
    v_mfma_f32_32x32x16_bf16 a[112:127], a[132:135], v[176:179], a[112:127]
    ds_read_b64_tr_b16 a[150:151], v193 offset:29696
    ds_read_b64_tr_b16 a[152:153], v192 offset:30720
    ds_read_b64_tr_b16 a[154:155], v192 offset:31744
    s_waitcnt lgkmcnt(6)
    v_mfma_f32_32x32x16_bf16 a[96:111], a[136:139], v[180:183], a[96:111]
    ds_read_b64_tr_b16 a[156:157], v193 offset:30720
    ds_read_b64_tr_b16 a[158:159], v193 offset:31744
    buffer_load_dwordx4 v[176:179], v224, s[28:31], s60 offen offset:0 sc1
    v_mfma_f32_32x32x16_bf16 a[112:127], a[140:143], v[180:183], a[112:127]
    buffer_load_dwordx4 v221, s[20:23], s56 offen offset:2048 lds
    buffer_load_dwordx4 v[180:183], v224, s[28:31], s60 offen offset:1024 sc1
    s_waitcnt vmcnt(29) lgkmcnt(4)
    v_mfma_f32_32x32x16_bf16 a[96:111], a[144:147], v[184:187], a[96:111]
    s_add_u32 s46, s45, s44
    s_add_u32 s45, s45, 0x8000
    s_cmp_eq_u32 s45, s76
    s_cselect_b32 s45, 0, s45
    v_mfma_f32_32x32x16_bf16 a[112:127], a[148:151], v[184:187], a[112:127]
    s_waitcnt lgkmcnt(0)
    v_mfma_f32_32x32x16_bf16 a[96:111], a[152:155], v[188:191], a[96:111]
    buffer_load_dwordx4 v[184:187], v224, s[28:31], s60 offen offset:2048 sc1
    v_mfma_f32_32x32x16_bf16 a[112:127], a[156:159], v[188:191], a[112:127]
    buffer_load_dwordx4 v222, s[20:23], s56 offen offset:3072 lds
    buffer_load_dwordx4 v[188:191], v224, s[28:31], s60 offen offset:3072 sc1
    s_add_u32 s54, s54, 0x100000
    s_xor_b32 s55, s54, s57
    s_add_u32 s56, s55, 0x80000
    s_add_u32 s61, s61, 0x20000
    s_xor_b32 s59, s61, s62
    s_add_u32 s60, s59, 0x10000
    s_mov_b32 m0, s46
    s_sub_u32 s47, s47, 1
    s_cbranch_scc0 LPP4
    s_setpc_b64 s[40:41]
LPN9:
    v_add_u32 v192, s45, v208
    v_xor_b32 v193, 64, v192
    s_waitcnt vmcnt(63) lgkmcnt(0)
    s_barrier
    ds_read_b64_tr_b16 a[128:129], v192 offset:0
    ds_read_b64_tr_b16 a[130:131], v192 offset:1024
    ds_read_b64_tr_b16 a[132:133], v193 offset:0
    ds_read_b64_tr_b16 a[134:135], v193 offset:1024
    ds_read_b64_tr_b16 a[136:137], v192 offset:2048
    ds_read_b64_tr_b16 a[138:139], v192 offset:3072
    ds_read_b64_tr_b16 a[140:141], v193 offset:2048
    ds_read_b64_tr_b16 a[142:143], v193 offset:3072
    s_waitcnt vmcnt(14) lgkmcnt(4)
    v_mfma_f32_32x32x16_bf16 a[96:111], a[128:131], v[128:131], a[96:111]
    ds_read_b64_tr_b16 a[144:145], v192 offset:4096
    ds_read_b64_tr_b16 a[146:147], v192 offset:5120
    ds_read_b64_tr_b16 a[148:149], v193 offset:4096
    v_mfma_f32_32x32x16_bf16 a[112:127], a[132:135], v[128:131], a[112:127]
    ds_read_b64_tr_b16 a[150:151], v193 offset:5120
    ds_read_b64_tr_b16 a[152:153], v192 offset:6144
    ds_read_b64_tr_b16 a[154:155], v192 offset:7168
    s_waitcnt lgkmcnt(6)
    v_mfma_f32_32x32x16_bf16 a[96:111], a[136:139], v[132:135], a[96:111]
    ds_read_b64_tr_b16 a[156:157], v193 offset:6144
    ds_read_b64_tr_b16 a[158:159], v193 offset:7168
    buffer_load_dwordx4 v[128:131], v223, s[28:31], s59 offen offset:0 sc1
    v_mfma_f32_32x32x16_bf16 a[112:127], a[140:143], v[132:135], a[112:127]
    buffer_load_dwordx4 v[132:135], v223, s[28:31], s59 offen offset:1024 sc1
    s_waitcnt vmcnt(14) lgkmcnt(4)
    v_mfma_f32_32x32x16_bf16 a[96:111], a[144:147], v[136:139], a[96:111]
    ds_read_b64_tr_b16 a[128:129], v192 offset:8192
    ds_read_b64_tr_b16 a[130:131], v192 offset:9216
    ds_read_b64_tr_b16 a[132:133], v193 offset:8192
    v_mfma_f32_32x32x16_bf16 a[112:127], a[148:151], v[136:139], a[112:127]
    ds_read_b64_tr_b16 a[134:135], v193 offset:9216
    ds_read_b64_tr_b16 a[136:137], v192 offset:10240
    ds_read_b64_tr_b16 a[138:139], v192 offset:11264
    s_waitcnt lgkmcnt(6)
    v_mfma_f32_32x32x16_bf16 a[96:111], a[152:155], v[140:143], a[96:111]
    ds_read_b64_tr_b16 a[140:141], v193 offset:10240
    ds_read_b64_tr_b16 a[142:143], v193 offset:11264
    buffer_load_dwordx4 v[136:139], v223, s[28:31], s59 offen offset:2048 sc1
    v_mfma_f32_32x32x16_bf16 a[112:127], a[156:159], v[140:143], a[112:127]
    buffer_load_dwordx4 v[140:143], v223, s[28:31], s59 offen offset:3072 sc1
    s_waitcnt vmcnt(14) lgkmcnt(4)
    v_mfma_f32_32x32x16_bf16 a[96:111], a[128:131], v[144:147], a[96:111]
    ds_read_b64_tr_b16 a[144:145], v192 offset:12288
    ds_read_b64_tr_b16 a[146:147], v192 offset:13312
    ds_read_b64_tr_b16 a[148:149], v193 offset:12288
    v_mfma_f32_32x32x16_bf16 a[112:127], a[132:135], v[144:147], a[112:127]
    ds_read_b64_tr_b16 a[150:151], v193 offset:13312
    ds_read_b64_tr_b16 a[152:153], v192 offset:14336
    ds_read_b64_tr_b16 a[154:155], v192 offset:15360
    s_waitcnt lgkmcnt(6)
    v_mfma_f32_32x32x16_bf16 a[96:111], a[136:139], v[148:151], a[96:111]
    ds_read_b64_tr_b16 a[156:157], v193 offset:14336
    ds_read_b64_tr_b16 a[158:159], v193 offset:15360
    buffer_load_dwordx4 v[144:147], v224, s[28:31], s59 offen offset:0 sc1
    v_mfma_f32_32x32x16_bf16 a[112:127], a[140:143], v[148:151], a[112:127]
    buffer_load_dwordx4 v[148:151], v224, s[28:31], s59 offen offset:1024 sc1
    s_waitcnt vmcnt(14) lgkmcnt(4)
    v_mfma_f32_32x32x16_bf16 a[96:111], a[144:147], v[152:155], a[96:111]
    ds_read_b64_tr_b16 a[128:129], v192 offset:16384
    ds_read_b64_tr_b16 a[130:131], v192 offset:17408
    ds_read_b64_tr_b16 a[132:133], v193 offset:16384
    v_mfma_f32_32x32x16_bf16 a[112:127], a[148:151], v[152:155], a[112:127]
    ds_read_b64_tr_b16 a[134:135], v193 offset:17408
    ds_read_b64_tr_b16 a[136:137], v192 offset:18432
    ds_read_b64_tr_b16 a[138:139], v192 offset:19456
    s_waitcnt lgkmcnt(6)
    v_mfma_f32_32x32x16_bf16 a[96:111], a[152:155], v[156:159], a[96:111]
    ds_read_b64_tr_b16 a[140:141], v193 offset:18432
    ds_read_b64_tr_b16 a[142:143], v193 offset:19456
    buffer_load_dwordx4 v[152:155], v224, s[28:31], s59 offen offset:2048 sc1
    v_mfma_f32_32x32x16_bf16 a[112:127], a[156:159], v[156:159], a[112:127]
    buffer_load_dwordx4 v[156:159], v224, s[28:31], s59 offen offset:3072 sc1
    s_waitcnt vmcnt(14) lgkmcnt(4)
    v_mfma_f32_32x32x16_bf16 a[96:111], a[128:131], v[160:163], a[96:111]
    ds_read_b64_tr_b16 a[144:145], v192 offset:20480
    ds_read_b64_tr_b16 a[146:147], v192 offset:21504
    ds_read_b64_tr_b16 a[148:149], v193 offset:20480
    v_mfma_f32_32x32x16_bf16 a[112:127], a[132:135], v[160:163], a[112:127]
    ds_read_b64_tr_b16 a[150:151], v193 offset:21504
    ds_read_b64_tr_b16 a[152:153], v192 offset:22528
    ds_read_b64_tr_b16 a[154:155], v192 offset:23552
    s_waitcnt lgkmcnt(6)
    v_mfma_f32_32x32x16_bf16 a[96:111], a[136:139], v[164:167], a[96:111]
    ds_read_b64_tr_b16 a[156:157], v193 offset:22528
    ds_read_b64_tr_b16 a[158:159], v193 offset:23552
    buffer_load_dwordx4 v[160:163], v223, s[28:31], s60 offen offset:0 sc1
    v_mfma_f32_32x32x16_bf16 a[112:127], a[140:143], v[164:167], a[112:127]
    buffer_load_dwordx4 v[164:167], v223, s[28:31], s60 offen offset:1024 sc1
    s_waitcnt vmcnt(14) lgkmcnt(4)
    v_mfma_f32_32x32x16_bf16 a[96:111], a[144:147], v[168:171], a[96:111]
    ds_read_b64_tr_b16 a[128:129], v192 offset:24576
    ds_read_b64_tr_b16 a[130:131], v192 offset:25600
    ds_read_b64_tr_b16 a[132:133], v193 offset:24576
    v_mfma_f32_32x32x16_bf16 a[112:127], a[148:151], v[168:171], a[112:127]
    ds_read_b64_tr_b16 a[134:135], v193 offset:25600
    ds_read_b64_tr_b16 a[136:137], v192 offset:26624
    ds_read_b64_tr_b16 a[138:139], v192 offset:27648
    s_waitcnt lgkmcnt(6)
    v_mfma_f32_32x32x16_bf16 a[96:111], a[152:155], v[172:175], a[96:111]
    ds_read_b64_tr_b16 a[140:141], v193 offset:26624
    ds_read_b64_tr_b16 a[142:143], v193 offset:27648
    buffer_load_dwordx4 v[168:171], v223, s[28:31], s60 offen offset:2048 sc1
    v_mfma_f32_32x32x16_bf16 a[112:127], a[156:159], v[172:175], a[112:127]
    buffer_load_dwordx4 v[172:175], v223, s[28:31], s60 offen offset:3072 sc1
    s_waitcnt vmcnt(14) lgkmcnt(4)
    v_mfma_f32_32x32x16_bf16 a[96:111], a[128:131], v[176:179], a[96:111]
    ds_read_b64_tr_b16 a[144:145], v192 offset:28672
    ds_read_b64_tr_b16 a[146:147], v192 offset:29696
    ds_read_b64_tr_b16 a[148:149], v193 offset:28672
    v_mfma_f32_32x32x16_bf16 a[112:127], a[132:135], v[176:179], a[112:127]
    ds_read_b64_tr_b16 a[150:151], v193 offset:29696
    ds_read_b64_tr_b16 a[152:153], v192 offset:30720
    ds_read_b64_tr_b16 a[154:155], v192 offset:31744
    s_waitcnt lgkmcnt(6)
    v_mfma_f32_32x32x16_bf16 a[96:111], a[136:139], v[180:183], a[96:111]
    ds_read_b64_tr_b16 a[156:157], v193 offset:30720
    ds_read_b64_tr_b16 a[158:159], v193 offset:31744
    buffer_load_dwordx4 v[176:179], v224, s[28:31], s60 offen offset:0 sc1
    v_mfma_f32_32x32x16_bf16 a[112:127], a[140:143], v[180:183], a[112:127]
    buffer_load_dwordx4 v[180:183], v224, s[28:31], s60 offen offset:1024 sc1
    s_waitcnt vmcnt(14) lgkmcnt(4)
    v_mfma_f32_32x32x16_bf16 a[96:111], a[144:147], v[184:187], a[96:111]
    s_add_u32 s46, s45, s44
    s_add_u32 s45, s45, 0x8000
    s_cmp_eq_u32 s45, s76
    s_cselect_b32 s45, 0, s45
    v_mfma_f32_32x32x16_bf16 a[112:127], a[148:151], v[184:187], a[112:127]
    s_waitcnt lgkmcnt(0)
    v_mfma_f32_32x32x16_bf16 a[96:111], a[152:155], v[188:191], a[96:111]
    buffer_load_dwordx4 v[184:187], v224, s[28:31], s60 offen offset:2048 sc1
    v_mfma_f32_32x32x16_bf16 a[112:127], a[156:159], v[188:191], a[112:127]
    buffer_load_dwordx4 v[188:191], v224, s[28:31], s60 offen offset:3072 sc1
    s_add_u32 s61, s61, 0x20000
    s_xor_b32 s59, s61, s62
    s_add_u32 s60, s59, 0x10000
    s_mov_b32 m0, s46
    s_sub_u32 s47, s47, 1
    s_cbranch_scc0 LPN9
    s_setpc_b64 s[40:41]
LrareA:
    v_max3_f32 v236, v64, v65, v66
    v_max3_f32 v236, v236, v67, v68
    v_max3_f32 v236, v236, v69, v70
    v_max3_f32 v236, v236, v71, v72
    v_max3_f32 v236, v236, v73, v74
    v_max3_f32 v236, v236, v75, v76
    v_max3_f32 v236, v236, v77, v78
    v_max_f32 v236, v236, v79
    v_mov_b32 v237, v236
    s_nop 1
    v_permlane32_swap_b32 v236, v237
    s_nop 1
    v_max_f32 v236, v236, v237
    v_add_f32 v236, 0x41000000, v236
    s_cselect_b32 s72, 1, 0
    s_cmp_eq_u32 s63, 0
    s_cbranch_scc1 LrareA_n
    v_mfma_f32_32x32x16_bf16 v[0:15], a[168:171], a[172:175], 0
    v_pk_add_f32 v[64:65], v[64:65], v[236:237] op_sel_hi:[1,0] neg_lo:[0,1] neg_hi:[0,1]
    v_pk_add_f32 v[66:67], v[66:67], v[236:237] op_sel_hi:[1,0] neg_lo:[0,1] neg_hi:[0,1]
    v_pk_add_f32 v[68:69], v[68:69], v[236:237] op_sel_hi:[1,0] neg_lo:[0,1] neg_hi:[0,1]
    v_pk_add_f32 v[70:71], v[70:71], v[236:237] op_sel_hi:[1,0] neg_lo:[0,1] neg_hi:[0,1]
    v_pk_add_f32 v[72:73], v[72:73], v[236:237] op_sel_hi:[1,0] neg_lo:[0,1] neg_hi:[0,1]
    v_pk_add_f32 v[74:75], v[74:75], v[236:237] op_sel_hi:[1,0] neg_lo:[0,1] neg_hi:[0,1]
    v_pk_add_f32 v[76:77], v[76:77], v[236:237] op_sel_hi:[1,0] neg_lo:[0,1] neg_hi:[0,1]
    v_pk_add_f32 v[78:79], v[78:79], v[236:237] op_sel_hi:[1,0] neg_lo:[0,1] neg_hi:[0,1]
    v_mfma_f32_32x32x16_bf16 v[16:31], a[168:171], a[172:175], 0
    v_pk_add_f32 v[80:81], v[80:81], v[236:237] op_sel_hi:[1,0] neg_lo:[0,1] neg_hi:[0,1]
    v_pk_add_f32 v[82:83], v[82:83], v[236:237] op_sel_hi:[1,0] neg_lo:[0,1] neg_hi:[0,1]
    v_pk_add_f32 v[84:85], v[84:85], v[236:237] op_sel_hi:[1,0] neg_lo:[0,1] neg_hi:[0,1]
    v_pk_add_f32 v[86:87], v[86:87], v[236:237] op_sel_hi:[1,0] neg_lo:[0,1] neg_hi:[0,1]
    v_pk_add_f32 v[88:89], v[88:89], v[236:237] op_sel_hi:[1,0] neg_lo:[0,1] neg_hi:[0,1]
    v_pk_add_f32 v[90:91], v[90:91], v[236:237] op_sel_hi:[1,0] neg_lo:[0,1] neg_hi:[0,1]
    v_pk_add_f32 v[92:93], v[92:93], v[236:237] op_sel_hi:[1,0] neg_lo:[0,1] neg_hi:[0,1]
    v_pk_add_f32 v[94:95], v[94:95], v[236:237] op_sel_hi:[1,0] neg_lo:[0,1] neg_hi:[0,1]
    v_mfma_f32_32x32x16_bf16 v[32:47], a[168:171], a[172:175], 0
    v_pk_add_f32 v[112:113], v[112:113], v[236:237] op_sel_hi:[1,0] neg_lo:[0,1] neg_hi:[0,1]
    v_pk_add_f32 v[114:115], v[114:115], v[236:237] op_sel_hi:[1,0] neg_lo:[0,1] neg_hi:[0,1]
    v_pk_add_f32 v[116:117], v[116:117], v[236:237] op_sel_hi:[1,0] neg_lo:[0,1] neg_hi:[0,1]
    v_pk_add_f32 v[118:119], v[118:119], v[236:237] op_sel_hi:[1,0] neg_lo:[0,1] neg_hi:[0,1]
    v_pk_add_f32 v[120:121], v[120:121], v[236:237] op_sel_hi:[1,0] neg_lo:[0,1] neg_hi:[0,1]
    v_pk_add_f32 v[122:123], v[122:123], v[236:237] op_sel_hi:[1,0] neg_lo:[0,1] neg_hi:[0,1]
    v_pk_add_f32 v[124:125], v[124:125], v[236:237] op_sel_hi:[1,0] neg_lo:[0,1] neg_hi:[0,1]
    v_pk_add_f32 v[126:127], v[126:127], v[236:237] op_sel_hi:[1,0] neg_lo:[0,1] neg_hi:[0,1]
    v_mfma_f32_32x32x16_bf16 v[48:63], a[168:171], a[172:175], 0
    v_mov_b32 v228, 0
    s_mov_b32 s63, 0
    s_mov_b32 s65, s64
    s_branch LrareA_x
LrareA_n:
    v_max_f32 v236, 0, v236
    v_exp_f32 v238, -v236
    v_pk_add_f32 v[64:65], v[64:65], v[236:237] op_sel_hi:[1,0] neg_lo:[0,1] neg_hi:[0,1]
    v_pk_add_f32 v[66:67], v[66:67], v[236:237] op_sel_hi:[1,0] neg_lo:[0,1] neg_hi:[0,1]
    v_pk_add_f32 v[68:69], v[68:69], v[236:237] op_sel_hi:[1,0] neg_lo:[0,1] neg_hi:[0,1]
    v_pk_add_f32 v[70:71], v[70:71], v[236:237] op_sel_hi:[1,0] neg_lo:[0,1] neg_hi:[0,1]
    v_pk_add_f32 v[72:73], v[72:73], v[236:237] op_sel_hi:[1,0] neg_lo:[0,1] neg_hi:[0,1]
    v_pk_add_f32 v[74:75], v[74:75], v[236:237] op_sel_hi:[1,0] neg_lo:[0,1] neg_hi:[0,1]
    v_pk_add_f32 v[76:77], v[76:77], v[236:237] op_sel_hi:[1,0] neg_lo:[0,1] neg_hi:[0,1]
    v_pk_add_f32 v[78:79], v[78:79], v[236:237] op_sel_hi:[1,0] neg_lo:[0,1] neg_hi:[0,1]
    v_pk_add_f32 v[80:81], v[80:81], v[236:237] op_sel_hi:[1,0] neg_lo:[0,1] neg_hi:[0,1]
    v_pk_add_f32 v[82:83], v[82:83], v[236:237] op_sel_hi:[1,0] neg_lo:[0,1] neg_hi:[0,1]
    v_pk_add_f32 v[84:85], v[84:85], v[236:237] op_sel_hi:[1,0] neg_lo:[0,1] neg_hi:[0,1]
    v_pk_add_f32 v[86:87], v[86:87], v[236:237] op_sel_hi:[1,0] neg_lo:[0,1] neg_hi:[0,1]
    v_pk_add_f32 v[88:89], v[88:89], v[236:237] op_sel_hi:[1,0] neg_lo:[0,1] neg_hi:[0,1]
    v_pk_add_f32 v[90:91], v[90:91], v[236:237] op_sel_hi:[1,0] neg_lo:[0,1] neg_hi:[0,1]
    v_pk_add_f32 v[92:93], v[92:93], v[236:237] op_sel_hi:[1,0] neg_lo:[0,1] neg_hi:[0,1]
    v_pk_add_f32 v[94:95], v[94:95], v[236:237] op_sel_hi:[1,0] neg_lo:[0,1] neg_hi:[0,1]
    v_pk_add_f32 v[112:113], v[112:113], v[236:237] op_sel_hi:[1,0] neg_lo:[0,1] neg_hi:[0,1]
    v_pk_add_f32 v[114:115], v[114:115], v[236:237] op_sel_hi:[1,0] neg_lo:[0,1] neg_hi:[0,1]
    v_pk_add_f32 v[116:117], v[116:117], v[236:237] op_sel_hi:[1,0] neg_lo:[0,1] neg_hi:[0,1]
    v_pk_add_f32 v[118:119], v[118:119], v[236:237] op_sel_hi:[1,0] neg_lo:[0,1] neg_hi:[0,1]
    v_pk_add_f32 v[120:121], v[120:121], v[236:237] op_sel_hi:[1,0] neg_lo:[0,1] neg_hi:[0,1]
    v_pk_add_f32 v[122:123], v[122:123], v[236:237] op_sel_hi:[1,0] neg_lo:[0,1] neg_hi:[0,1]
    v_pk_add_f32 v[124:125], v[124:125], v[236:237] op_sel_hi:[1,0] neg_lo:[0,1] neg_hi:[0,1]
    v_pk_add_f32 v[126:127], v[126:127], v[236:237] op_sel_hi:[1,0] neg_lo:[0,1] neg_hi:[0,1]
    v_pk_mul_f32 v[0:1], v[0:1], v[238:239] op_sel_hi:[1,0]
    v_pk_mul_f32 v[2:3], v[2:3], v[238:239] op_sel_hi:[1,0]
    v_pk_mul_f32 v[4:5], v[4:5], v[238:239] op_sel_hi:[1,0]
    v_pk_mul_f32 v[6:7], v[6:7], v[238:239] op_sel_hi:[1,0]
    v_pk_mul_f32 v[8:9], v[8:9], v[238:239] op_sel_hi:[1,0]
    v_pk_mul_f32 v[10:11], v[10:11], v[238:239] op_sel_hi:[1,0]
    v_pk_mul_f32 v[12:13], v[12:13], v[238:239] op_sel_hi:[1,0]
    v_pk_mul_f32 v[14:15], v[14:15], v[238:239] op_sel_hi:[1,0]
    v_pk_mul_f32 v[16:17], v[16:17], v[238:239] op_sel_hi:[1,0]
    v_pk_mul_f32 v[18:19], v[18:19], v[238:239] op_sel_hi:[1,0]
    v_pk_mul_f32 v[20:21], v[20:21], v[238:239] op_sel_hi:[1,0]
    v_pk_mul_f32 v[22:23], v[22:23], v[238:239] op_sel_hi:[1,0]
    v_pk_mul_f32 v[24:25], v[24:25], v[238:239] op_sel_hi:[1,0]
    v_pk_mul_f32 v[26:27], v[26:27], v[238:239] op_sel_hi:[1,0]
    v_pk_mul_f32 v[28:29], v[28:29], v[238:239] op_sel_hi:[1,0]
    v_pk_mul_f32 v[30:31], v[30:31], v[238:239] op_sel_hi:[1,0]
    v_pk_mul_f32 v[32:33], v[32:33], v[238:239] op_sel_hi:[1,0]
    v_pk_mul_f32 v[34:35], v[34:35], v[238:239] op_sel_hi:[1,0]
    v_pk_mul_f32 v[36:37], v[36:37], v[238:239] op_sel_hi:[1,0]
    v_pk_mul_f32 v[38:39], v[38:39], v[238:239] op_sel_hi:[1,0]
    v_pk_mul_f32 v[40:41], v[40:41], v[238:239] op_sel_hi:[1,0]
    v_pk_mul_f32 v[42:43], v[42:43], v[238:239] op_sel_hi:[1,0]
    v_pk_mul_f32 v[44:45], v[44:45], v[238:239] op_sel_hi:[1,0]
    v_pk_mul_f32 v[46:47], v[46:47], v[238:239] op_sel_hi:[1,0]
    v_pk_mul_f32 v[48:49], v[48:49], v[238:239] op_sel_hi:[1,0]
    v_pk_mul_f32 v[50:51], v[50:51], v[238:239] op_sel_hi:[1,0]
    v_pk_mul_f32 v[52:53], v[52:53], v[238:239] op_sel_hi:[1,0]
    v_pk_mul_f32 v[54:55], v[54:55], v[238:239] op_sel_hi:[1,0]
    v_pk_mul_f32 v[56:57], v[56:57], v[238:239] op_sel_hi:[1,0]
    v_pk_mul_f32 v[58:59], v[58:59], v[238:239] op_sel_hi:[1,0]
    v_pk_mul_f32 v[60:61], v[60:61], v[238:239] op_sel_hi:[1,0]
    v_pk_mul_f32 v[62:63], v[62:63], v[238:239] op_sel_hi:[1,0]
    v_mul_f32 v228, v228, v238
LrareA_x:
    v_exp_f32 v232, v64
    v_exp_f32 v233, v65
    v_exp_f32 v234, v66
    v_cvt_pk_bf16_f32 v96, v232, v233
    v_exp_f32 v235, v67
    v_exp_f32 v232, v68
    v_cvt_pk_bf16_f32 v97, v234, v235
    v_exp_f32 v233, v69
    v_exp_f32 v234, v70
    v_cvt_pk_bf16_f32 v98, v232, v233
    v_exp_f32 v235, v71
    v_exp_f32 v232, v72
    v_cvt_pk_bf16_f32 v99, v234, v235
    v_exp_f32 v233, v73
    v_exp_f32 v234, v74
    v_cvt_pk_bf16_f32 v100, v232, v233
    v_exp_f32 v235, v75
    v_exp_f32 v232, v76
    v_cvt_pk_bf16_f32 v101, v234, v235
    v_exp_f32 v233, v77
    v_exp_f32 v234, v78
    v_cvt_pk_bf16_f32 v102, v232, v233
    v_exp_f32 v235, v79
    s_nop 0
    v_cvt_pk_bf16_f32 v103, v234, v235
    s_cmp_lg_u32 s72, 0
    s_setpc_b64 s[42:43]
LrareB:
    v_max3_f32 v236, v80, v81, v82
    v_max3_f32 v236, v236, v83, v84
    v_max3_f32 v236, v236, v85, v86
    v_max3_f32 v236, v236, v87, v88
    v_max3_f32 v236, v236, v89, v90
    v_max3_f32 v236, v236, v91, v92
    v_max3_f32 v236, v236, v93, v94
    v_max_f32 v236, v236, v95
    v_mov_b32 v237, v236
    s_nop 1
    v_permlane32_swap_b32 v236, v237
    s_nop 1
    v_max_f32 v236, v236, v237
    v_add_f32 v236, 0x41000000, v236
    v_max_f32 v236, 0, v236
    v_exp_f32 v238, -v236
    v_pk_add_f32 v[80:81], v[80:81], v[236:237] op_sel_hi:[1,0] neg_lo:[0,1] neg_hi:[0,1]
    v_pk_add_f32 v[82:83], v[82:83], v[236:237] op_sel_hi:[1,0] neg_lo:[0,1] neg_hi:[0,1]
    v_pk_add_f32 v[84:85], v[84:85], v[236:237] op_sel_hi:[1,0] neg_lo:[0,1] neg_hi:[0,1]
    v_pk_add_f32 v[86:87], v[86:87], v[236:237] op_sel_hi:[1,0] neg_lo:[0,1] neg_hi:[0,1]
    v_pk_add_f32 v[88:89], v[88:89], v[236:237] op_sel_hi:[1,0] neg_lo:[0,1] neg_hi:[0,1]
    v_pk_add_f32 v[90:91], v[90:91], v[236:237] op_sel_hi:[1,0] neg_lo:[0,1] neg_hi:[0,1]
    v_pk_add_f32 v[92:93], v[92:93], v[236:237] op_sel_hi:[1,0] neg_lo:[0,1] neg_hi:[0,1]
    v_pk_add_f32 v[94:95], v[94:95], v[236:237] op_sel_hi:[1,0] neg_lo:[0,1] neg_hi:[0,1]
    v_pk_add_f32 v[64:65], v[64:65], v[236:237] op_sel_hi:[1,0] neg_lo:[0,1] neg_hi:[0,1]
    v_pk_add_f32 v[66:67], v[66:67], v[236:237] op_sel_hi:[1,0] neg_lo:[0,1] neg_hi:[0,1]
    v_pk_add_f32 v[68:69], v[68:69], v[236:237] op_sel_hi:[1,0] neg_lo:[0,1] neg_hi:[0,1]
    v_pk_add_f32 v[70:71], v[70:71], v[236:237] op_sel_hi:[1,0] neg_lo:[0,1] neg_hi:[0,1]
    v_pk_add_f32 v[72:73], v[72:73], v[236:237] op_sel_hi:[1,0] neg_lo:[0,1] neg_hi:[0,1]
    v_pk_add_f32 v[74:75], v[74:75], v[236:237] op_sel_hi:[1,0] neg_lo:[0,1] neg_hi:[0,1]
    v_pk_add_f32 v[76:77], v[76:77], v[236:237] op_sel_hi:[1,0] neg_lo:[0,1] neg_hi:[0,1]
    v_pk_add_f32 v[78:79], v[78:79], v[236:237] op_sel_hi:[1,0] neg_lo:[0,1] neg_hi:[0,1]
    v_pk_add_f32 v[112:113], v[112:113], v[236:237] op_sel_hi:[1,0] neg_lo:[0,1] neg_hi:[0,1]
    v_pk_add_f32 v[114:115], v[114:115], v[236:237] op_sel_hi:[1,0] neg_lo:[0,1] neg_hi:[0,1]
    v_pk_add_f32 v[116:117], v[116:117], v[236:237] op_sel_hi:[1,0] neg_lo:[0,1] neg_hi:[0,1]
    v_pk_add_f32 v[118:119], v[118:119], v[236:237] op_sel_hi:[1,0] neg_lo:[0,1] neg_hi:[0,1]
    v_pk_add_f32 v[120:121], v[120:121], v[236:237] op_sel_hi:[1,0] neg_lo:[0,1] neg_hi:[0,1]
    v_pk_add_f32 v[122:123], v[122:123], v[236:237] op_sel_hi:[1,0] neg_lo:[0,1] neg_hi:[0,1]
    v_pk_add_f32 v[124:125], v[124:125], v[236:237] op_sel_hi:[1,0] neg_lo:[0,1] neg_hi:[0,1]
    v_pk_add_f32 v[126:127], v[126:127], v[236:237] op_sel_hi:[1,0] neg_lo:[0,1] neg_hi:[0,1]
    v_pk_mul_f32 v[0:1], v[0:1], v[238:239] op_sel_hi:[1,0]
    v_pk_mul_f32 v[2:3], v[2:3], v[238:239] op_sel_hi:[1,0]
    v_pk_mul_f32 v[4:5], v[4:5], v[238:239] op_sel_hi:[1,0]
    v_pk_mul_f32 v[6:7], v[6:7], v[238:239] op_sel_hi:[1,0]
    v_pk_mul_f32 v[8:9], v[8:9], v[238:239] op_sel_hi:[1,0]
    v_pk_mul_f32 v[10:11], v[10:11], v[238:239] op_sel_hi:[1,0]
    v_pk_mul_f32 v[12:13], v[12:13], v[238:239] op_sel_hi:[1,0]
    v_pk_mul_f32 v[14:15], v[14:15], v[238:239] op_sel_hi:[1,0]
    v_pk_mul_f32 v[16:17], v[16:17], v[238:239] op_sel_hi:[1,0]
    v_pk_mul_f32 v[18:19], v[18:19], v[238:239] op_sel_hi:[1,0]
    v_pk_mul_f32 v[20:21], v[20:21], v[238:239] op_sel_hi:[1,0]
    v_pk_mul_f32 v[22:23], v[22:23], v[238:239] op_sel_hi:[1,0]
    v_pk_mul_f32 v[24:25], v[24:25], v[238:239] op_sel_hi:[1,0]
    v_pk_mul_f32 v[26:27], v[26:27], v[238:239] op_sel_hi:[1,0]
    v_pk_mul_f32 v[28:29], v[28:29], v[238:239] op_sel_hi:[1,0]
    v_pk_mul_f32 v[30:31], v[30:31], v[238:239] op_sel_hi:[1,0]
    v_pk_mul_f32 v[32:33], v[32:33], v[238:239] op_sel_hi:[1,0]
    v_pk_mul_f32 v[34:35], v[34:35], v[238:239] op_sel_hi:[1,0]
    v_pk_mul_f32 v[36:37], v[36:37], v[238:239] op_sel_hi:[1,0]
    v_pk_mul_f32 v[38:39], v[38:39], v[238:239] op_sel_hi:[1,0]
    v_pk_mul_f32 v[40:41], v[40:41], v[238:239] op_sel_hi:[1,0]
    v_pk_mul_f32 v[42:43], v[42:43], v[238:239] op_sel_hi:[1,0]
    v_pk_mul_f32 v[44:45], v[44:45], v[238:239] op_sel_hi:[1,0]
    v_pk_mul_f32 v[46:47], v[46:47], v[238:239] op_sel_hi:[1,0]
    v_pk_mul_f32 v[48:49], v[48:49], v[238:239] op_sel_hi:[1,0]
    v_pk_mul_f32 v[50:51], v[50:51], v[238:239] op_sel_hi:[1,0]
    v_pk_mul_f32 v[52:53], v[52:53], v[238:239] op_sel_hi:[1,0]
    v_pk_mul_f32 v[54:55], v[54:55], v[238:239] op_sel_hi:[1,0]
    v_pk_mul_f32 v[56:57], v[56:57], v[238:239] op_sel_hi:[1,0]
    v_pk_mul_f32 v[58:59], v[58:59], v[238:239] op_sel_hi:[1,0]
    v_pk_mul_f32 v[60:61], v[60:61], v[238:239] op_sel_hi:[1,0]
    v_pk_mul_f32 v[62:63], v[62:63], v[238:239] op_sel_hi:[1,0]
    v_mul_f32 v228, v228, v238
LrareB_x:
    v_exp_f32 v232, v80
    v_exp_f32 v233, v81
    v_exp_f32 v234, v82
    v_cvt_pk_bf16_f32 v104, v232, v233
    v_exp_f32 v235, v83
    v_exp_f32 v232, v84
    v_cvt_pk_bf16_f32 v105, v234, v235
    v_exp_f32 v233, v85
    v_exp_f32 v234, v86
    v_cvt_pk_bf16_f32 v106, v232, v233
    v_exp_f32 v235, v87
    v_exp_f32 v232, v88
    v_cvt_pk_bf16_f32 v107, v234, v235
    v_exp_f32 v233, v89
    v_exp_f32 v234, v90
    v_cvt_pk_bf16_f32 v108, v232, v233
    v_exp_f32 v235, v91
    v_exp_f32 v232, v92
    v_cvt_pk_bf16_f32 v109, v234, v235
    v_exp_f32 v233, v93
    v_exp_f32 v234, v94
    v_cvt_pk_bf16_f32 v110, v232, v233
    v_exp_f32 v235, v95
    s_nop 0
    v_cvt_pk_bf16_f32 v111, v234, v235
    s_setpc_b64 s[42:43]
Ltr_5:
    s_call_b64 s[42:43], LrareB
    s_branch Lbk_6
Ltr_7:
    s_call_b64 s[42:43], LrareA
    s_branch Lbk_8
Ltr_17:
    s_call_b64 s[42:43], LrareB
    s_branch Lbk_18
Ltr_19:
    s_call_b64 s[42:43], LrareA
    s_branch Lbk_20
Ltr_26:
    s_call_b64 s[42:43], LrareB
    s_branch Lbk_27
Ltr_28:
    s_call_b64 s[42:43], LrareA
    s_branch Lbk_29
Ltr_30:
    s_call_b64 s[42:43], LrareB
    s_branch Lbk_31
Ltr_32:
    s_call_b64 s[42:43], LrareB
    s_branch Lbk_33
Ltr_34:
    s_call_b64 s[42:43], LrareA
    s_branch Lbk_35
Ltr_36:
    s_call_b64 s[42:43], LrareB
    s_branch Lbk_37
Ltr_38:
    s_call_b64 s[42:43], LrareA
    s_branch Lbk_39
    s_endpgm
Lcodeend:
.section .rodata,"a"
.p2align 6
.amdhsa_kernel concat_heads__mha_block_cached__mha_block_cached__near_ridge_kernel
  .amdhsa_next_free_vgpr 436
  .amdhsa_next_free_sgpr 102
  .amdhsa_accum_offset 256
  .amdhsa_group_segment_fixed_size 0
  .amdhsa_kernarg_size 104
  .amdhsa_user_sgpr_count 2
  .amdhsa_user_sgpr_kernarg_segment_ptr 1
  .amdhsa_system_sgpr_workgroup_id_x 1
  .amdhsa_float_denorm_mode_32 3
.end_amdhsa_kernel
```
